```python
import torch

def _softmax(x, axis=-1):
    return torch.softmax(x, dim=axis)
def _gelu(x):
    return torch.nn.functional.gelu(x, approximate="tanh")
def _silu(x):
    return torch.nn.functional.silu(x)
def _sigmoid(x):
    return torch.sigmoid(x)
def _layernorm(x, axis=-1, eps=1e-5):
    m = x.mean(dim=axis, keepdim=True)
    v = x.var(dim=axis, keepdim=True, unbiased=False)
    return (x - m) / torch.sqrt(v + eps)
def _scatter_add(tgt, idx, src, axis=0):
    return tgt.clone().index_add_(axis, idx, src)
def _segment_sum(src, seg, n):
    out = torch.zeros((n,) + src.shape[1:], dtype=src.dtype)
    return out.index_add_(0, seg, src)
def _pad(x, pw):
    flat = tuple(v for pair in reversed(pw) for v in pair)
    return torch.nn.functional.pad(x, flat)

kernel_name = 'standalone__layernorm_linear__sampling'

def setup_inputs():

    _w = (lambda a: (lambda t: t.to(torch.bfloat16) if t.is_floating_point() else t)(torch.as_tensor(a)))
    B, S, D = 1024, 8, 640
    return {
        "x": _w((lambda *s: torch.randn(*s, dtype=torch.bfloat16) * 0.05)(B, S, D)),
        "g": _w((lambda *s: torch.randn(*s, dtype=torch.bfloat16) * 0.05)(D) + 1.0),
        "b": _w((lambda *s: torch.randn(*s, dtype=torch.bfloat16) * 0.4)(D)),
        "w": _w((lambda *s: torch.randn(*s, dtype=torch.bfloat16) * 0.05)(D, D)),
    }

def reference(x, g, b, w):
    return (_layernorm(x, axis=-1) * g + b) @ w
```

```asm
; @launch grid=(256,1,1) block=(256,1,1) lds=144384
.amdgcn_target "amdgcn-amd-amdhsa--gfx950"
.text
.globl standalone__layernorm_linear__sampling_kernel
.p2align 8
.type standalone__layernorm_linear__sampling_kernel,@function
standalone__layernorm_linear__sampling_kernel:
    s_cmp_ge_u32 s2, 256
    s_cbranch_scc1 L_end
    s_load_dwordx4 s[4:7], s[0:1], 0
    s_load_dwordx4 s[8:11], s[0:1], 16
    s_load_dwordx2 s[12:13], s[0:1], 32
    v_lshrrev_b32 v2, 6, v0
    v_and_b32 v1, 63, v0
    s_lshr_b32 s3, s2, 4
    s_lshl_b32 s3, s3, 3
    s_and_b32 s14, s2, 7
    s_add_u32 s3, s3, s14
    s_lshl_b32 s36, s3, 6
    s_lshr_b32 s14, s2, 3
    s_and_b32 s14, s14, 1
    s_mul_i32 s37, s14, 320
    v_readfirstlane_b32 s38, v2
    s_nop 3
    s_mul_i32 s39, s38, 80
    s_add_u32 s39, s39, s37
    s_waitcnt lgkmcnt(0)
    s_mov_b32 s16, s4
    s_and_b32 s17, s5, 0xffff
    s_mov_b32 s18, 10485760
    s_mov_b32 s19, 0x20000
    s_mov_b32 s20, s6
    s_and_b32 s21, s7, 0xffff
    s_mov_b32 s22, 1280
    s_mov_b32 s23, 0x20000
    s_mov_b32 s24, s8
    s_and_b32 s25, s9, 0xffff
    s_mov_b32 s26, 1280
    s_mov_b32 s27, 0x20000
    s_mov_b32 s28, s10
    s_and_b32 s29, s11, 0xffff
    s_mov_b32 s30, 819200
    s_mov_b32 s31, 0x20000
    s_mov_b32 s32, s12
    s_and_b32 s33, s13, 0xffff
    s_mov_b32 s34, 10485760
    s_mov_b32 s35, 0x20000
    s_mov_b32 s14, 6554
    v_add_u32 v3, 0, v1
    v_mul_lo_u32 v4, v3, s14
    v_lshrrev_b32 v4, 16, v4
    v_mul_u32_u24 v5, 10, v4
    v_sub_u32 v5, v3, v5
    v_and_b32 v6, 15, v4
    v_lshrrev_b32 v6, 2, v6
    v_lshlrev_b32 v6, 3, v6
    v_and_b32 v7, 3, v4
    v_add_u32 v6, v6, v7
    v_lshrrev_b32 v7, 4, v4
    v_lshlrev_b32 v7, 2, v7
    v_add_u32 v6, v6, v7
    v_mul_u32_u24 v6, 0x500, v6
    v_lshlrev_b32 v5, 4, v5
    v_add_u32 v6, v6, v5
    s_lshl_b32 s15, s39, 1
    v_add_u32 v240, s15, v6
    v_add_u32 v3, 64, v1
    v_mul_lo_u32 v4, v3, s14
    v_lshrrev_b32 v4, 16, v4
    v_mul_u32_u24 v5, 10, v4
    v_sub_u32 v5, v3, v5
    v_and_b32 v6, 15, v4
    v_lshrrev_b32 v6, 2, v6
    v_lshlrev_b32 v6, 3, v6
    v_and_b32 v7, 3, v4
    v_add_u32 v6, v6, v7
    v_lshrrev_b32 v7, 4, v4
    v_lshlrev_b32 v7, 2, v7
    v_add_u32 v6, v6, v7
    v_mul_u32_u24 v6, 0x500, v6
    v_lshlrev_b32 v5, 4, v5
    v_add_u32 v6, v6, v5
    s_lshl_b32 s15, s39, 1
    v_add_u32 v241, s15, v6
    v_add_u32 v3, 128, v1
    v_mul_lo_u32 v4, v3, s14
    v_lshrrev_b32 v4, 16, v4
    v_mul_u32_u24 v5, 10, v4
    v_sub_u32 v5, v3, v5
    v_and_b32 v6, 15, v4
    v_lshrrev_b32 v6, 2, v6
    v_lshlrev_b32 v6, 3, v6
    v_and_b32 v7, 3, v4
    v_add_u32 v6, v6, v7
    v_lshrrev_b32 v7, 4, v4
    v_lshlrev_b32 v7, 2, v7
    v_add_u32 v6, v6, v7
    v_mul_u32_u24 v6, 0x500, v6
    v_lshlrev_b32 v5, 4, v5
    v_add_u32 v6, v6, v5
    s_lshl_b32 s15, s39, 1
    v_add_u32 v242, s15, v6
    v_add_u32 v3, 192, v1
    v_mul_lo_u32 v4, v3, s14
    v_lshrrev_b32 v4, 16, v4
    v_mul_u32_u24 v5, 10, v4
    v_sub_u32 v5, v3, v5
    v_and_b32 v6, 15, v4
    v_lshrrev_b32 v6, 2, v6
    v_lshlrev_b32 v6, 3, v6
    v_and_b32 v7, 3, v4
    v_add_u32 v6, v6, v7
    v_lshrrev_b32 v7, 4, v4
    v_lshlrev_b32 v7, 2, v7
    v_add_u32 v6, v6, v7
    v_mul_u32_u24 v6, 0x500, v6
    v_lshlrev_b32 v5, 4, v5
    v_add_u32 v6, v6, v5
    s_lshl_b32 s15, s39, 1
    v_add_u32 v243, s15, v6
    v_add_u32 v3, 256, v1
    v_mul_lo_u32 v4, v3, s14
    v_lshrrev_b32 v4, 16, v4
    v_mul_u32_u24 v5, 10, v4
    v_sub_u32 v5, v3, v5
    v_and_b32 v6, 15, v4
    v_lshrrev_b32 v6, 2, v6
    v_lshlrev_b32 v6, 3, v6
    v_and_b32 v7, 3, v4
    v_add_u32 v6, v6, v7
    v_lshrrev_b32 v7, 4, v4
    v_lshlrev_b32 v7, 2, v7
    v_add_u32 v6, v6, v7
    v_mul_u32_u24 v6, 0x500, v6
    v_lshlrev_b32 v5, 4, v5
    v_add_u32 v6, v6, v5
    s_lshl_b32 s15, s39, 1
    v_add_u32 v244, s15, v6
    s_mul_i32 s42, s38, 15360
    s_add_u32 s42, s42, 82944
    s_mov_b32 s41, 0
    s_add_u32 s43, s42, 0
    s_mov_b32 m0, s43
    s_nop 0
    buffer_load_dwordx4 v240, s[28:31], s41 offen lds
    s_add_u32 s43, s42, 1024
    s_mov_b32 m0, s43
    s_nop 0
    buffer_load_dwordx4 v241, s[28:31], s41 offen lds
    s_add_u32 s43, s42, 2048
    s_mov_b32 m0, s43
    s_nop 0
    buffer_load_dwordx4 v242, s[28:31], s41 offen lds
    s_add_u32 s43, s42, 3072
    s_mov_b32 m0, s43
    s_nop 0
    buffer_load_dwordx4 v243, s[28:31], s41 offen lds
    s_add_u32 s43, s42, 4096
    s_mov_b32 m0, s43
    s_nop 0
    buffer_load_dwordx4 v244, s[28:31], s41 offen lds
    s_mov_b32 s41, 40960
    s_add_u32 s43, s42, 5120
    s_mov_b32 m0, s43
    s_nop 0
    buffer_load_dwordx4 v240, s[28:31], s41 offen lds
    s_add_u32 s43, s42, 6144
    s_mov_b32 m0, s43
    s_nop 0
    buffer_load_dwordx4 v241, s[28:31], s41 offen lds
    s_add_u32 s43, s42, 7168
    s_mov_b32 m0, s43
    s_nop 0
    buffer_load_dwordx4 v242, s[28:31], s41 offen lds
    s_add_u32 s43, s42, 8192
    s_mov_b32 m0, s43
    s_nop 0
    buffer_load_dwordx4 v243, s[28:31], s41 offen lds
    s_add_u32 s43, s42, 9216
    s_mov_b32 m0, s43
    s_nop 0
    buffer_load_dwordx4 v244, s[28:31], s41 offen lds
    v_lshrrev_b32 v3, 4, v1
    v_and_b32 v4, 15, v1
    s_lshl_b32 s14, s38, 4
    s_add_u32 s14, s14, s36
    v_add_u32 v5, s14, v3
    s_mov_b32 s15, 1280
    v_mul_lo_u32 v5, v5, s15
    v_lshlrev_b32 v6, 4, v4
    v_add_u32 v5, v5, v6
    buffer_load_dwordx4 v[180:183], v6, s[20:23], 0 offen offset:0
    buffer_load_dwordx4 v[184:187], v6, s[20:23], 0 offen offset:256
    buffer_load_dwordx4 v[188:191], v6, s[20:23], 0 offen offset:512
    buffer_load_dwordx4 v[192:195], v6, s[20:23], 0 offen offset:768
    buffer_load_dwordx4 v[196:199], v6, s[20:23], 0 offen offset:1024
    buffer_load_dwordx4 v[200:203], v6, s[24:27], 0 offen offset:0
    buffer_load_dwordx4 v[204:207], v6, s[24:27], 0 offen offset:256
    buffer_load_dwordx4 v[208:211], v6, s[24:27], 0 offen offset:512
    buffer_load_dwordx4 v[212:215], v6, s[24:27], 0 offen offset:768
    buffer_load_dwordx4 v[216:219], v6, s[24:27], 0 offen offset:1024
    buffer_load_dwordx4 v[20:23], v5, s[16:19], 0 offen offset:0
    buffer_load_dwordx4 v[24:27], v5, s[16:19], 0 offen offset:256
    buffer_load_dwordx4 v[28:31], v5, s[16:19], 0 offen offset:512
    buffer_load_dwordx4 v[32:35], v5, s[16:19], 0 offen offset:768
    buffer_load_dwordx4 v[36:39], v5, s[16:19], 0 offen offset:1024
    v_add_u32 v5, 5120, v5
    buffer_load_dwordx4 v[40:43], v5, s[16:19], 0 offen offset:0
    buffer_load_dwordx4 v[44:47], v5, s[16:19], 0 offen offset:256
    buffer_load_dwordx4 v[48:51], v5, s[16:19], 0 offen offset:512
    buffer_load_dwordx4 v[52:55], v5, s[16:19], 0 offen offset:768
    buffer_load_dwordx4 v[56:59], v5, s[16:19], 0 offen offset:1024
    v_add_u32 v5, 5120, v5
    buffer_load_dwordx4 v[60:63], v5, s[16:19], 0 offen offset:0
    buffer_load_dwordx4 v[64:67], v5, s[16:19], 0 offen offset:256
    buffer_load_dwordx4 v[68:71], v5, s[16:19], 0 offen offset:512
    buffer_load_dwordx4 v[72:75], v5, s[16:19], 0 offen offset:768
    buffer_load_dwordx4 v[76:79], v5, s[16:19], 0 offen offset:1024
    v_add_u32 v5, 5120, v5
    buffer_load_dwordx4 v[80:83], v5, s[16:19], 0 offen offset:0
    buffer_load_dwordx4 v[84:87], v5, s[16:19], 0 offen offset:256
    buffer_load_dwordx4 v[88:91], v5, s[16:19], 0 offen offset:512
    buffer_load_dwordx4 v[92:95], v5, s[16:19], 0 offen offset:768
    buffer_load_dwordx4 v[96:99], v5, s[16:19], 0 offen offset:1024
    s_lshl_b32 s14, s38, 4
    v_add_u32 v7, s14, v3
    s_mov_b32 s15, 1296
    v_mul_lo_u32 v7, v7, s15
    v_add_u32 v7, v7, v6
    s_mov_b32 s44, 0xffff0000
    s_mov_b32 s45, 0x3f803f80
    s_mov_b32 s46, 0x3acccccd
    s_mov_b32 s47, 0x3727c5ac
    s_waitcnt vmcnt(20)
    v_lshlrev_b32 v100, 16, v180
    v_and_b32 v101, s44, v180
    v_lshlrev_b32 v102, 16, v181
    v_and_b32 v103, s44, v181
    v_lshlrev_b32 v104, 16, v182
    v_and_b32 v105, s44, v182
    v_lshlrev_b32 v106, 16, v183
    v_and_b32 v107, s44, v183
    v_lshlrev_b32 v108, 16, v184
    v_and_b32 v109, s44, v184
    v_lshlrev_b32 v110, 16, v185
    v_and_b32 v111, s44, v185
    v_lshlrev_b32 v112, 16, v186
    v_and_b32 v113, s44, v186
    v_lshlrev_b32 v114, 16, v187
    v_and_b32 v115, s44, v187
    v_lshlrev_b32 v116, 16, v188
    v_and_b32 v117, s44, v188
    v_lshlrev_b32 v118, 16, v189
    v_and_b32 v119, s44, v189
    v_lshlrev_b32 v120, 16, v190
    v_and_b32 v121, s44, v190
    v_lshlrev_b32 v122, 16, v191
    v_and_b32 v123, s44, v191
    v_lshlrev_b32 v124, 16, v192
    v_and_b32 v125, s44, v192
    v_lshlrev_b32 v126, 16, v193
    v_and_b32 v127, s44, v193
    v_lshlrev_b32 v128, 16, v194
    v_and_b32 v129, s44, v194
    v_lshlrev_b32 v130, 16, v195
    v_and_b32 v131, s44, v195
    v_lshlrev_b32 v132, 16, v196
    v_and_b32 v133, s44, v196
    v_lshlrev_b32 v134, 16, v197
    v_and_b32 v135, s44, v197
    v_lshlrev_b32 v136, 16, v198
    v_and_b32 v137, s44, v198
    v_lshlrev_b32 v138, 16, v199
    v_and_b32 v139, s44, v199
    v_lshlrev_b32 v140, 16, v200
    v_and_b32 v141, s44, v200
    v_lshlrev_b32 v142, 16, v201
    v_and_b32 v143, s44, v201
    v_lshlrev_b32 v144, 16, v202
    v_and_b32 v145, s44, v202
    v_lshlrev_b32 v146, 16, v203
    v_and_b32 v147, s44, v203
    v_lshlrev_b32 v148, 16, v204
    v_and_b32 v149, s44, v204
    v_lshlrev_b32 v150, 16, v205
    v_and_b32 v151, s44, v205
    v_lshlrev_b32 v152, 16, v206
    v_and_b32 v153, s44, v206
    v_lshlrev_b32 v154, 16, v207
    v_and_b32 v155, s44, v207
    v_lshlrev_b32 v156, 16, v208
    v_and_b32 v157, s44, v208
    v_lshlrev_b32 v158, 16, v209
    v_and_b32 v159, s44, v209
    v_lshlrev_b32 v160, 16, v210
    v_and_b32 v161, s44, v210
    v_lshlrev_b32 v162, 16, v211
    v_and_b32 v163, s44, v211
    v_lshlrev_b32 v164, 16, v212
    v_and_b32 v165, s44, v212
    v_lshlrev_b32 v166, 16, v213
    v_and_b32 v167, s44, v213
    v_lshlrev_b32 v168, 16, v214
    v_and_b32 v169, s44, v214
    v_lshlrev_b32 v170, 16, v215
    v_and_b32 v171, s44, v215
    v_lshlrev_b32 v172, 16, v216
    v_and_b32 v173, s44, v216
    v_lshlrev_b32 v174, 16, v217
    v_and_b32 v175, s44, v217
    v_lshlrev_b32 v176, 16, v218
    v_and_b32 v177, s44, v218
    v_lshlrev_b32 v178, 16, v219
    v_and_b32 v179, s44, v219
    s_waitcnt vmcnt(15)
    v_mov_b32 v220, 0
    v_dot2c_f32_bf16 v220, s45, v20
    v_dot2c_f32_bf16 v220, s45, v21
    v_dot2c_f32_bf16 v220, s45, v22
    v_dot2c_f32_bf16 v220, s45, v23
    v_dot2c_f32_bf16 v220, s45, v24
    v_dot2c_f32_bf16 v220, s45, v25
    v_dot2c_f32_bf16 v220, s45, v26
    v_dot2c_f32_bf16 v220, s45, v27
    v_dot2c_f32_bf16 v220, s45, v28
    v_dot2c_f32_bf16 v220, s45, v29
    v_dot2c_f32_bf16 v220, s45, v30
    v_dot2c_f32_bf16 v220, s45, v31
    v_dot2c_f32_bf16 v220, s45, v32
    v_dot2c_f32_bf16 v220, s45, v33
    v_dot2c_f32_bf16 v220, s45, v34
    v_dot2c_f32_bf16 v220, s45, v35
    v_dot2c_f32_bf16 v220, s45, v36
    v_dot2c_f32_bf16 v220, s45, v37
    v_dot2c_f32_bf16 v220, s45, v38
    v_dot2c_f32_bf16 v220, s45, v39
    s_nop 1
    v_add_f32_dpp v220, v220, v220 row_ror:8 row_mask:0xf bank_mask:0xf
    s_nop 1
    v_add_f32_dpp v220, v220, v220 row_ror:4 row_mask:0xf bank_mask:0xf
    s_nop 1
    v_add_f32_dpp v220, v220, v220 row_ror:2 row_mask:0xf bank_mask:0xf
    s_nop 1
    v_add_f32_dpp v220, v220, v220 row_ror:1 row_mask:0xf bank_mask:0xf
    v_mul_f32 v220, s46, v220
    v_mov_b32 v221, 0
    v_lshlrev_b32 v180, 16, v20
    v_and_b32 v181, s44, v20
    v_sub_f32 v180, v180, v220
    v_sub_f32 v181, v181, v220
    v_fmac_f32 v221, v180, v180
    v_fmac_f32 v221, v181, v181
    v_lshlrev_b32 v182, 16, v21
    v_and_b32 v183, s44, v21
    v_sub_f32 v182, v182, v220
    v_sub_f32 v183, v183, v220
    v_fmac_f32 v221, v182, v182
    v_fmac_f32 v221, v183, v183
    v_lshlrev_b32 v184, 16, v22
    v_and_b32 v185, s44, v22
    v_sub_f32 v184, v184, v220
    v_sub_f32 v185, v185, v220
    v_fmac_f32 v221, v184, v184
    v_fmac_f32 v221, v185, v185
    v_lshlrev_b32 v186, 16, v23
    v_and_b32 v187, s44, v23
    v_sub_f32 v186, v186, v220
    v_sub_f32 v187, v187, v220
    v_fmac_f32 v221, v186, v186
    v_fmac_f32 v221, v187, v187
    v_lshlrev_b32 v188, 16, v24
    v_and_b32 v189, s44, v24
    v_sub_f32 v188, v188, v220
    v_sub_f32 v189, v189, v220
    v_fmac_f32 v221, v188, v188
    v_fmac_f32 v221, v189, v189
    v_lshlrev_b32 v190, 16, v25
    v_and_b32 v191, s44, v25
    v_sub_f32 v190, v190, v220
    v_sub_f32 v191, v191, v220
    v_fmac_f32 v221, v190, v190
    v_fmac_f32 v221, v191, v191
    v_lshlrev_b32 v192, 16, v26
    v_and_b32 v193, s44, v26
    v_sub_f32 v192, v192, v220
    v_sub_f32 v193, v193, v220
    v_fmac_f32 v221, v192, v192
    v_fmac_f32 v221, v193, v193
    v_lshlrev_b32 v194, 16, v27
    v_and_b32 v195, s44, v27
    v_sub_f32 v194, v194, v220
    v_sub_f32 v195, v195, v220
    v_fmac_f32 v221, v194, v194
    v_fmac_f32 v221, v195, v195
    v_lshlrev_b32 v196, 16, v28
    v_and_b32 v197, s44, v28
    v_sub_f32 v196, v196, v220
    v_sub_f32 v197, v197, v220
    v_fmac_f32 v221, v196, v196
    v_fmac_f32 v221, v197, v197
    v_lshlrev_b32 v198, 16, v29
    v_and_b32 v199, s44, v29
    v_sub_f32 v198, v198, v220
    v_sub_f32 v199, v199, v220
    v_fmac_f32 v221, v198, v198
    v_fmac_f32 v221, v199, v199
    v_lshlrev_b32 v200, 16, v30
    v_and_b32 v201, s44, v30
    v_sub_f32 v200, v200, v220
    v_sub_f32 v201, v201, v220
    v_fmac_f32 v221, v200, v200
    v_fmac_f32 v221, v201, v201
    v_lshlrev_b32 v202, 16, v31
    v_and_b32 v203, s44, v31
    v_sub_f32 v202, v202, v220
    v_sub_f32 v203, v203, v220
    v_fmac_f32 v221, v202, v202
    v_fmac_f32 v221, v203, v203
    v_lshlrev_b32 v204, 16, v32
    v_and_b32 v205, s44, v32
    v_sub_f32 v204, v204, v220
    v_sub_f32 v205, v205, v220
    v_fmac_f32 v221, v204, v204
    v_fmac_f32 v221, v205, v205
    v_lshlrev_b32 v206, 16, v33
    v_and_b32 v207, s44, v33
    v_sub_f32 v206, v206, v220
    v_sub_f32 v207, v207, v220
    v_fmac_f32 v221, v206, v206
    v_fmac_f32 v221, v207, v207
    v_lshlrev_b32 v208, 16, v34
    v_and_b32 v209, s44, v34
    v_sub_f32 v208, v208, v220
    v_sub_f32 v209, v209, v220
    v_fmac_f32 v221, v208, v208
    v_fmac_f32 v221, v209, v209
    v_lshlrev_b32 v210, 16, v35
    v_and_b32 v211, s44, v35
    v_sub_f32 v210, v210, v220
    v_sub_f32 v211, v211, v220
    v_fmac_f32 v221, v210, v210
    v_fmac_f32 v221, v211, v211
    v_lshlrev_b32 v212, 16, v36
    v_and_b32 v213, s44, v36
    v_sub_f32 v212, v212, v220
    v_sub_f32 v213, v213, v220
    v_fmac_f32 v221, v212, v212
    v_fmac_f32 v221, v213, v213
    v_lshlrev_b32 v214, 16, v37
    v_and_b32 v215, s44, v37
    v_sub_f32 v214, v214, v220
    v_sub_f32 v215, v215, v220
    v_fmac_f32 v221, v214, v214
    v_fmac_f32 v221, v215, v215
    v_lshlrev_b32 v216, 16, v38
    v_and_b32 v217, s44, v38
    v_sub_f32 v216, v216, v220
    v_sub_f32 v217, v217, v220
    v_fmac_f32 v221, v216, v216
    v_fmac_f32 v221, v217, v217
    v_lshlrev_b32 v218, 16, v39
    v_and_b32 v219, s44, v39
    v_sub_f32 v218, v218, v220
    v_sub_f32 v219, v219, v220
    v_fmac_f32 v221, v218, v218
    v_fmac_f32 v221, v219, v219
    s_nop 1
    v_add_f32_dpp v221, v221, v221 row_ror:8 row_mask:0xf bank_mask:0xf
    s_nop 1
    v_add_f32_dpp v221, v221, v221 row_ror:4 row_mask:0xf bank_mask:0xf
    s_nop 1
    v_add_f32_dpp v221, v221, v221 row_ror:2 row_mask:0xf bank_mask:0xf
    s_nop 1
    v_add_f32_dpp v221, v221, v221 row_ror:1 row_mask:0xf bank_mask:0xf
    v_mov_b32 v222, s47
    v_fmac_f32 v222, s46, v221
    v_rsq_f32 v222, v222
    s_nop 0
    v_mul_f32 v180, v180, v222
    v_mul_f32 v181, v181, v222
    v_fma_f32 v180, v180, v100, v140
    v_fma_f32 v181, v181, v101, v141
    v_cvt_pk_bf16_f32 v224, v180, v181
    v_mul_f32 v182, v182, v222
    v_mul_f32 v183, v183, v222
    v_fma_f32 v182, v182, v102, v142
    v_fma_f32 v183, v183, v103, v143
    v_cvt_pk_bf16_f32 v225, v182, v183
    v_mul_f32 v184, v184, v222
    v_mul_f32 v185, v185, v222
    v_fma_f32 v184, v184, v104, v144
    v_fma_f32 v185, v185, v105, v145
    v_cvt_pk_bf16_f32 v226, v184, v185
    v_mul_f32 v186, v186, v222
    v_mul_f32 v187, v187, v222
    v_fma_f32 v186, v186, v106, v146
    v_fma_f32 v187, v187, v107, v147
    v_cvt_pk_bf16_f32 v227, v186, v187
    ds_write_b128 v7, v[224:227] offset:0
    s_nop 1
    v_mul_f32 v188, v188, v222
    v_mul_f32 v189, v189, v222
    v_fma_f32 v188, v188, v108, v148
    v_fma_f32 v189, v189, v109, v149
    v_cvt_pk_bf16_f32 v224, v188, v189
    v_mul_f32 v190, v190, v222
    v_mul_f32 v191, v191, v222
    v_fma_f32 v190, v190, v110, v150
    v_fma_f32 v191, v191, v111, v151
    v_cvt_pk_bf16_f32 v225, v190, v191
    v_mul_f32 v192, v192, v222
    v_mul_f32 v193, v193, v222
    v_fma_f32 v192, v192, v112, v152
    v_fma_f32 v193, v193, v113, v153
    v_cvt_pk_bf16_f32 v226, v192, v193
    v_mul_f32 v194, v194, v222
    v_mul_f32 v195, v195, v222
    v_fma_f32 v194, v194, v114, v154
    v_fma_f32 v195, v195, v115, v155
    v_cvt_pk_bf16_f32 v227, v194, v195
    ds_write_b128 v7, v[224:227] offset:256
    s_nop 1
    v_mul_f32 v196, v196, v222
    v_mul_f32 v197, v197, v222
    v_fma_f32 v196, v196, v116, v156
    v_fma_f32 v197, v197, v117, v157
    v_cvt_pk_bf16_f32 v224, v196, v197
    v_mul_f32 v198, v198, v222
    v_mul_f32 v199, v199, v222
    v_fma_f32 v198, v198, v118, v158
    v_fma_f32 v199, v199, v119, v159
    v_cvt_pk_bf16_f32 v225, v198, v199
    v_mul_f32 v200, v200, v222
    v_mul_f32 v201, v201, v222
    v_fma_f32 v200, v200, v120, v160
    v_fma_f32 v201, v201, v121, v161
    v_cvt_pk_bf16_f32 v226, v200, v201
    v_mul_f32 v202, v202, v222
    v_mul_f32 v203, v203, v222
    v_fma_f32 v202, v202, v122, v162
    v_fma_f32 v203, v203, v123, v163
    v_cvt_pk_bf16_f32 v227, v202, v203
    ds_write_b128 v7, v[224:227] offset:512
    s_nop 1
    v_mul_f32 v204, v204, v222
    v_mul_f32 v205, v205, v222
    v_fma_f32 v204, v204, v124, v164
    v_fma_f32 v205, v205, v125, v165
    v_cvt_pk_bf16_f32 v224, v204, v205
    v_mul_f32 v206, v206, v222
    v_mul_f32 v207, v207, v222
    v_fma_f32 v206, v206, v126, v166
    v_fma_f32 v207, v207, v127, v167
    v_cvt_pk_bf16_f32 v225, v206, v207
    v_mul_f32 v208, v208, v222
    v_mul_f32 v209, v209, v222
    v_fma_f32 v208, v208, v128, v168
    v_fma_f32 v209, v209, v129, v169
    v_cvt_pk_bf16_f32 v226, v208, v209
    v_mul_f32 v210, v210, v222
    v_mul_f32 v211, v211, v222
    v_fma_f32 v210, v210, v130, v170
    v_fma_f32 v211, v211, v131, v171
    v_cvt_pk_bf16_f32 v227, v210, v211
    ds_write_b128 v7, v[224:227] offset:768
    s_nop 1
    v_mul_f32 v212, v212, v222
    v_mul_f32 v213, v213, v222
    v_fma_f32 v212, v212, v132, v172
    v_fma_f32 v213, v213, v133, v173
    v_cvt_pk_bf16_f32 v224, v212, v213
    v_mul_f32 v214, v214, v222
    v_mul_f32 v215, v215, v222
    v_fma_f32 v214, v214, v134, v174
    v_fma_f32 v215, v215, v135, v175
    v_cvt_pk_bf16_f32 v225, v214, v215
    v_mul_f32 v216, v216, v222
    v_mul_f32 v217, v217, v222
    v_fma_f32 v216, v216, v136, v176
    v_fma_f32 v217, v217, v137, v177
    v_cvt_pk_bf16_f32 v226, v216, v217
    v_mul_f32 v218, v218, v222
    v_mul_f32 v219, v219, v222
    v_fma_f32 v218, v218, v138, v178
    v_fma_f32 v219, v219, v139, v179
    v_cvt_pk_bf16_f32 v227, v218, v219
    ds_write_b128 v7, v[224:227] offset:1024
    s_nop 1
    s_waitcnt vmcnt(10)
    v_mov_b32 v220, 0
    v_dot2c_f32_bf16 v220, s45, v40
    v_dot2c_f32_bf16 v220, s45, v41
    v_dot2c_f32_bf16 v220, s45, v42
    v_dot2c_f32_bf16 v220, s45, v43
    v_dot2c_f32_bf16 v220, s45, v44
    v_dot2c_f32_bf16 v220, s45, v45
    v_dot2c_f32_bf16 v220, s45, v46
    v_dot2c_f32_bf16 v220, s45, v47
    v_dot2c_f32_bf16 v220, s45, v48
    v_dot2c_f32_bf16 v220, s45, v49
    v_dot2c_f32_bf16 v220, s45, v50
    v_dot2c_f32_bf16 v220, s45, v51
    v_dot2c_f32_bf16 v220, s45, v52
    v_dot2c_f32_bf16 v220, s45, v53
    v_dot2c_f32_bf16 v220, s45, v54
    v_dot2c_f32_bf16 v220, s45, v55
    v_dot2c_f32_bf16 v220, s45, v56
    v_dot2c_f32_bf16 v220, s45, v57
    v_dot2c_f32_bf16 v220, s45, v58
    v_dot2c_f32_bf16 v220, s45, v59
    s_nop 1
    v_add_f32_dpp v220, v220, v220 row_ror:8 row_mask:0xf bank_mask:0xf
    s_nop 1
    v_add_f32_dpp v220, v220, v220 row_ror:4 row_mask:0xf bank_mask:0xf
    s_nop 1
    v_add_f32_dpp v220, v220, v220 row_ror:2 row_mask:0xf bank_mask:0xf
    s_nop 1
    v_add_f32_dpp v220, v220, v220 row_ror:1 row_mask:0xf bank_mask:0xf
    v_mul_f32 v220, s46, v220
    v_mov_b32 v221, 0
    v_lshlrev_b32 v180, 16, v40
    v_and_b32 v181, s44, v40
    v_sub_f32 v180, v180, v220
    v_sub_f32 v181, v181, v220
    v_fmac_f32 v221, v180, v180
    v_fmac_f32 v221, v181, v181
    v_lshlrev_b32 v182, 16, v41
    v_and_b32 v183, s44, v41
    v_sub_f32 v182, v182, v220
    v_sub_f32 v183, v183, v220
    v_fmac_f32 v221, v182, v182
    v_fmac_f32 v221, v183, v183
    v_lshlrev_b32 v184, 16, v42
    v_and_b32 v185, s44, v42
    v_sub_f32 v184, v184, v220
    v_sub_f32 v185, v185, v220
    v_fmac_f32 v221, v184, v184
    v_fmac_f32 v221, v185, v185
    v_lshlrev_b32 v186, 16, v43
    v_and_b32 v187, s44, v43
    v_sub_f32 v186, v186, v220
    v_sub_f32 v187, v187, v220
    v_fmac_f32 v221, v186, v186
    v_fmac_f32 v221, v187, v187
    v_lshlrev_b32 v188, 16, v44
    v_and_b32 v189, s44, v44
    v_sub_f32 v188, v188, v220
    v_sub_f32 v189, v189, v220
    v_fmac_f32 v221, v188, v188
    v_fmac_f32 v221, v189, v189
    v_lshlrev_b32 v190, 16, v45
    v_and_b32 v191, s44, v45
    v_sub_f32 v190, v190, v220
    v_sub_f32 v191, v191, v220
    v_fmac_f32 v221, v190, v190
    v_fmac_f32 v221, v191, v191
    v_lshlrev_b32 v192, 16, v46
    v_and_b32 v193, s44, v46
    v_sub_f32 v192, v192, v220
    v_sub_f32 v193, v193, v220
    v_fmac_f32 v221, v192, v192
    v_fmac_f32 v221, v193, v193
    v_lshlrev_b32 v194, 16, v47
    v_and_b32 v195, s44, v47
    v_sub_f32 v194, v194, v220
    v_sub_f32 v195, v195, v220
    v_fmac_f32 v221, v194, v194
    v_fmac_f32 v221, v195, v195
    v_lshlrev_b32 v196, 16, v48
    v_and_b32 v197, s44, v48
    v_sub_f32 v196, v196, v220
    v_sub_f32 v197, v197, v220
    v_fmac_f32 v221, v196, v196
    v_fmac_f32 v221, v197, v197
    v_lshlrev_b32 v198, 16, v49
    v_and_b32 v199, s44, v49
    v_sub_f32 v198, v198, v220
    v_sub_f32 v199, v199, v220
    v_fmac_f32 v221, v198, v198
    v_fmac_f32 v221, v199, v199
    v_lshlrev_b32 v200, 16, v50
    v_and_b32 v201, s44, v50
    v_sub_f32 v200, v200, v220
    v_sub_f32 v201, v201, v220
    v_fmac_f32 v221, v200, v200
    v_fmac_f32 v221, v201, v201
    v_lshlrev_b32 v202, 16, v51
    v_and_b32 v203, s44, v51
    v_sub_f32 v202, v202, v220
    v_sub_f32 v203, v203, v220
    v_fmac_f32 v221, v202, v202
    v_fmac_f32 v221, v203, v203
    v_lshlrev_b32 v204, 16, v52
    v_and_b32 v205, s44, v52
    v_sub_f32 v204, v204, v220
    v_sub_f32 v205, v205, v220
    v_fmac_f32 v221, v204, v204
    v_fmac_f32 v221, v205, v205
    v_lshlrev_b32 v206, 16, v53
    v_and_b32 v207, s44, v53
    v_sub_f32 v206, v206, v220
    v_sub_f32 v207, v207, v220
    v_fmac_f32 v221, v206, v206
    v_fmac_f32 v221, v207, v207
    v_lshlrev_b32 v208, 16, v54
    v_and_b32 v209, s44, v54
    v_sub_f32 v208, v208, v220
    v_sub_f32 v209, v209, v220
    v_fmac_f32 v221, v208, v208
    v_fmac_f32 v221, v209, v209
    v_lshlrev_b32 v210, 16, v55
    v_and_b32 v211, s44, v55
    v_sub_f32 v210, v210, v220
    v_sub_f32 v211, v211, v220
    v_fmac_f32 v221, v210, v210
    v_fmac_f32 v221, v211, v211
    v_lshlrev_b32 v212, 16, v56
    v_and_b32 v213, s44, v56
    v_sub_f32 v212, v212, v220
    v_sub_f32 v213, v213, v220
    v_fmac_f32 v221, v212, v212
    v_fmac_f32 v221, v213, v213
    v_lshlrev_b32 v214, 16, v57
    v_and_b32 v215, s44, v57
    v_sub_f32 v214, v214, v220
    v_sub_f32 v215, v215, v220
    v_fmac_f32 v221, v214, v214
    v_fmac_f32 v221, v215, v215
    v_lshlrev_b32 v216, 16, v58
    v_and_b32 v217, s44, v58
    v_sub_f32 v216, v216, v220
    v_sub_f32 v217, v217, v220
    v_fmac_f32 v221, v216, v216
    v_fmac_f32 v221, v217, v217
    v_lshlrev_b32 v218, 16, v59
    v_and_b32 v219, s44, v59
    v_sub_f32 v218, v218, v220
    v_sub_f32 v219, v219, v220
    v_fmac_f32 v221, v218, v218
    v_fmac_f32 v221, v219, v219
    s_nop 1
    v_add_f32_dpp v221, v221, v221 row_ror:8 row_mask:0xf bank_mask:0xf
    s_nop 1
    v_add_f32_dpp v221, v221, v221 row_ror:4 row_mask:0xf bank_mask:0xf
    s_nop 1
    v_add_f32_dpp v221, v221, v221 row_ror:2 row_mask:0xf bank_mask:0xf
    s_nop 1
    v_add_f32_dpp v221, v221, v221 row_ror:1 row_mask:0xf bank_mask:0xf
    v_mov_b32 v222, s47
    v_fmac_f32 v222, s46, v221
    v_rsq_f32 v222, v222
    s_nop 0
    v_mul_f32 v180, v180, v222
    v_mul_f32 v181, v181, v222
    v_fma_f32 v180, v180, v100, v140
    v_fma_f32 v181, v181, v101, v141
    v_cvt_pk_bf16_f32 v224, v180, v181
    v_mul_f32 v182, v182, v222
    v_mul_f32 v183, v183, v222
    v_fma_f32 v182, v182, v102, v142
    v_fma_f32 v183, v183, v103, v143
    v_cvt_pk_bf16_f32 v225, v182, v183
    v_mul_f32 v184, v184, v222
    v_mul_f32 v185, v185, v222
    v_fma_f32 v184, v184, v104, v144
    v_fma_f32 v185, v185, v105, v145
    v_cvt_pk_bf16_f32 v226, v184, v185
    v_mul_f32 v186, v186, v222
    v_mul_f32 v187, v187, v222
    v_fma_f32 v186, v186, v106, v146
    v_fma_f32 v187, v187, v107, v147
    v_cvt_pk_bf16_f32 v227, v186, v187
    ds_write_b128 v7, v[224:227] offset:5184
    s_nop 1
    v_mul_f32 v188, v188, v222
    v_mul_f32 v189, v189, v222
    v_fma_f32 v188, v188, v108, v148
    v_fma_f32 v189, v189, v109, v149
    v_cvt_pk_bf16_f32 v224, v188, v189
    v_mul_f32 v190, v190, v222
    v_mul_f32 v191, v191, v222
    v_fma_f32 v190, v190, v110, v150
    v_fma_f32 v191, v191, v111, v151
    v_cvt_pk_bf16_f32 v225, v190, v191
    v_mul_f32 v192, v192, v222
    v_mul_f32 v193, v193, v222
    v_fma_f32 v192, v192, v112, v152
    v_fma_f32 v193, v193, v113, v153
    v_cvt_pk_bf16_f32 v226, v192, v193
    v_mul_f32 v194, v194, v222
    v_mul_f32 v195, v195, v222
    v_fma_f32 v194, v194, v114, v154
    v_fma_f32 v195, v195, v115, v155
    v_cvt_pk_bf16_f32 v227, v194, v195
    ds_write_b128 v7, v[224:227] offset:5440
    s_nop 1
    v_mul_f32 v196, v196, v222
    v_mul_f32 v197, v197, v222
    v_fma_f32 v196, v196, v116, v156
    v_fma_f32 v197, v197, v117, v157
    v_cvt_pk_bf16_f32 v224, v196, v197
    v_mul_f32 v198, v198, v222
    v_mul_f32 v199, v199, v222
    v_fma_f32 v198, v198, v118, v158
    v_fma_f32 v199, v199, v119, v159
    v_cvt_pk_bf16_f32 v225, v198, v199
    v_mul_f32 v200, v200, v222
    v_mul_f32 v201, v201, v222
    v_fma_f32 v200, v200, v120, v160
    v_fma_f32 v201, v201, v121, v161
    v_cvt_pk_bf16_f32 v226, v200, v201
    v_mul_f32 v202, v202, v222
    v_mul_f32 v203, v203, v222
    v_fma_f32 v202, v202, v122, v162
    v_fma_f32 v203, v203, v123, v163
    v_cvt_pk_bf16_f32 v227, v202, v203
    ds_write_b128 v7, v[224:227] offset:5696
    s_nop 1
    v_mul_f32 v204, v204, v222
    v_mul_f32 v205, v205, v222
    v_fma_f32 v204, v204, v124, v164
    v_fma_f32 v205, v205, v125, v165
    v_cvt_pk_bf16_f32 v224, v204, v205
    v_mul_f32 v206, v206, v222
    v_mul_f32 v207, v207, v222
    v_fma_f32 v206, v206, v126, v166
    v_fma_f32 v207, v207, v127, v167
    v_cvt_pk_bf16_f32 v225, v206, v207
    v_mul_f32 v208, v208, v222
    v_mul_f32 v209, v209, v222
    v_fma_f32 v208, v208, v128, v168
    v_fma_f32 v209, v209, v129, v169
    v_cvt_pk_bf16_f32 v226, v208, v209
    v_mul_f32 v210, v210, v222
    v_mul_f32 v211, v211, v222
    v_fma_f32 v210, v210, v130, v170
    v_fma_f32 v211, v211, v131, v171
    v_cvt_pk_bf16_f32 v227, v210, v211
    ds_write_b128 v7, v[224:227] offset:5952
    s_nop 1
    v_mul_f32 v212, v212, v222
    v_mul_f32 v213, v213, v222
    v_fma_f32 v212, v212, v132, v172
    v_fma_f32 v213, v213, v133, v173
    v_cvt_pk_bf16_f32 v224, v212, v213
    v_mul_f32 v214, v214, v222
    v_mul_f32 v215, v215, v222
    v_fma_f32 v214, v214, v134, v174
    v_fma_f32 v215, v215, v135, v175
    v_cvt_pk_bf16_f32 v225, v214, v215
    v_mul_f32 v216, v216, v222
    v_mul_f32 v217, v217, v222
    v_fma_f32 v216, v216, v136, v176
    v_fma_f32 v217, v217, v137, v177
    v_cvt_pk_bf16_f32 v226, v216, v217
    v_mul_f32 v218, v218, v222
    v_mul_f32 v219, v219, v222
    v_fma_f32 v218, v218, v138, v178
    v_fma_f32 v219, v219, v139, v179
    v_cvt_pk_bf16_f32 v227, v218, v219
    ds_write_b128 v7, v[224:227] offset:6208
    s_nop 1
    s_waitcnt vmcnt(5)
    v_mov_b32 v220, 0
    v_dot2c_f32_bf16 v220, s45, v60
    v_dot2c_f32_bf16 v220, s45, v61
    v_dot2c_f32_bf16 v220, s45, v62
    v_dot2c_f32_bf16 v220, s45, v63
    v_dot2c_f32_bf16 v220, s45, v64
    v_dot2c_f32_bf16 v220, s45, v65
    v_dot2c_f32_bf16 v220, s45, v66
    v_dot2c_f32_bf16 v220, s45, v67
    v_dot2c_f32_bf16 v220, s45, v68
    v_dot2c_f32_bf16 v220, s45, v69
    v_dot2c_f32_bf16 v220, s45, v70
    v_dot2c_f32_bf16 v220, s45, v71
    v_dot2c_f32_bf16 v220, s45, v72
    v_dot2c_f32_bf16 v220, s45, v73
    v_dot2c_f32_bf16 v220, s45, v74
    v_dot2c_f32_bf16 v220, s45, v75
    v_dot2c_f32_bf16 v220, s45, v76
    v_dot2c_f32_bf16 v220, s45, v77
    v_dot2c_f32_bf16 v220, s45, v78
    v_dot2c_f32_bf16 v220, s45, v79
    s_nop 1
    v_add_f32_dpp v220, v220, v220 row_ror:8 row_mask:0xf bank_mask:0xf
    s_nop 1
    v_add_f32_dpp v220, v220, v220 row_ror:4 row_mask:0xf bank_mask:0xf
    s_nop 1
    v_add_f32_dpp v220, v220, v220 row_ror:2 row_mask:0xf bank_mask:0xf
    s_nop 1
    v_add_f32_dpp v220, v220, v220 row_ror:1 row_mask:0xf bank_mask:0xf
    v_mul_f32 v220, s46, v220
    v_mov_b32 v221, 0
    v_lshlrev_b32 v180, 16, v60
    v_and_b32 v181, s44, v60
    v_sub_f32 v180, v180, v220
    v_sub_f32 v181, v181, v220
    v_fmac_f32 v221, v180, v180
    v_fmac_f32 v221, v181, v181
    v_lshlrev_b32 v182, 16, v61
    v_and_b32 v183, s44, v61
    v_sub_f32 v182, v182, v220
    v_sub_f32 v183, v183, v220
    v_fmac_f32 v221, v182, v182
    v_fmac_f32 v221, v183, v183
    v_lshlrev_b32 v184, 16, v62
    v_and_b32 v185, s44, v62
    v_sub_f32 v184, v184, v220
    v_sub_f32 v185, v185, v220
    v_fmac_f32 v221, v184, v184
    v_fmac_f32 v221, v185, v185
    v_lshlrev_b32 v186, 16, v63
    v_and_b32 v187, s44, v63
    v_sub_f32 v186, v186, v220
    v_sub_f32 v187, v187, v220
    v_fmac_f32 v221, v186, v186
    v_fmac_f32 v221, v187, v187
    v_lshlrev_b32 v188, 16, v64
    v_and_b32 v189, s44, v64
    v_sub_f32 v188, v188, v220
    v_sub_f32 v189, v189, v220
    v_fmac_f32 v221, v188, v188
    v_fmac_f32 v221, v189, v189
    v_lshlrev_b32 v190, 16, v65
    v_and_b32 v191, s44, v65
    v_sub_f32 v190, v190, v220
    v_sub_f32 v191, v191, v220
    v_fmac_f32 v221, v190, v190
    v_fmac_f32 v221, v191, v191
    v_lshlrev_b32 v192, 16, v66
    v_and_b32 v193, s44, v66
    v_sub_f32 v192, v192, v220
    v_sub_f32 v193, v193, v220
    v_fmac_f32 v221, v192, v192
    v_fmac_f32 v221, v193, v193
    v_lshlrev_b32 v194, 16, v67
    v_and_b32 v195, s44, v67
    v_sub_f32 v194, v194, v220
    v_sub_f32 v195, v195, v220
    v_fmac_f32 v221, v194, v194
    v_fmac_f32 v221, v195, v195
    v_lshlrev_b32 v196, 16, v68
    v_and_b32 v197, s44, v68
    v_sub_f32 v196, v196, v220
    v_sub_f32 v197, v197, v220
    v_fmac_f32 v221, v196, v196
    v_fmac_f32 v221, v197, v197
    v_lshlrev_b32 v198, 16, v69
    v_and_b32 v199, s44, v69
    v_sub_f32 v198, v198, v220
    v_sub_f32 v199, v199, v220
    v_fmac_f32 v221, v198, v198
    v_fmac_f32 v221, v199, v199
    v_lshlrev_b32 v200, 16, v70
    v_and_b32 v201, s44, v70
    v_sub_f32 v200, v200, v220
    v_sub_f32 v201, v201, v220
    v_fmac_f32 v221, v200, v200
    v_fmac_f32 v221, v201, v201
    v_lshlrev_b32 v202, 16, v71
    v_and_b32 v203, s44, v71
    v_sub_f32 v202, v202, v220
    v_sub_f32 v203, v203, v220
    v_fmac_f32 v221, v202, v202
    v_fmac_f32 v221, v203, v203
    v_lshlrev_b32 v204, 16, v72
    v_and_b32 v205, s44, v72
    v_sub_f32 v204, v204, v220
    v_sub_f32 v205, v205, v220
    v_fmac_f32 v221, v204, v204
    v_fmac_f32 v221, v205, v205
    v_lshlrev_b32 v206, 16, v73
    v_and_b32 v207, s44, v73
    v_sub_f32 v206, v206, v220
    v_sub_f32 v207, v207, v220
    v_fmac_f32 v221, v206, v206
    v_fmac_f32 v221, v207, v207
    v_lshlrev_b32 v208, 16, v74
    v_and_b32 v209, s44, v74
    v_sub_f32 v208, v208, v220
    v_sub_f32 v209, v209, v220
    v_fmac_f32 v221, v208, v208
    v_fmac_f32 v221, v209, v209
    v_lshlrev_b32 v210, 16, v75
    v_and_b32 v211, s44, v75
    v_sub_f32 v210, v210, v220
    v_sub_f32 v211, v211, v220
    v_fmac_f32 v221, v210, v210
    v_fmac_f32 v221, v211, v211
    v_lshlrev_b32 v212, 16, v76
    v_and_b32 v213, s44, v76
    v_sub_f32 v212, v212, v220
    v_sub_f32 v213, v213, v220
    v_fmac_f32 v221, v212, v212
    v_fmac_f32 v221, v213, v213
    v_lshlrev_b32 v214, 16, v77
    v_and_b32 v215, s44, v77
    v_sub_f32 v214, v214, v220
    v_sub_f32 v215, v215, v220
    v_fmac_f32 v221, v214, v214
    v_fmac_f32 v221, v215, v215
    v_lshlrev_b32 v216, 16, v78
    v_and_b32 v217, s44, v78
    v_sub_f32 v216, v216, v220
    v_sub_f32 v217, v217, v220
    v_fmac_f32 v221, v216, v216
    v_fmac_f32 v221, v217, v217
    v_lshlrev_b32 v218, 16, v79
    v_and_b32 v219, s44, v79
    v_sub_f32 v218, v218, v220
    v_sub_f32 v219, v219, v220
    v_fmac_f32 v221, v218, v218
    v_fmac_f32 v221, v219, v219
    s_nop 1
    v_add_f32_dpp v221, v221, v221 row_ror:8 row_mask:0xf bank_mask:0xf
    s_nop 1
    v_add_f32_dpp v221, v221, v221 row_ror:4 row_mask:0xf bank_mask:0xf
    s_nop 1
    v_add_f32_dpp v221, v221, v221 row_ror:2 row_mask:0xf bank_mask:0xf
    s_nop 1
    v_add_f32_dpp v221, v221, v221 row_ror:1 row_mask:0xf bank_mask:0xf
    v_mov_b32 v222, s47
    v_fmac_f32 v222, s46, v221
    v_rsq_f32 v222, v222
    s_nop 0
    v_mul_f32 v180, v180, v222
    v_mul_f32 v181, v181, v222
    v_fma_f32 v180, v180, v100, v140
    v_fma_f32 v181, v181, v101, v141
    v_cvt_pk_bf16_f32 v224, v180, v181
    v_mul_f32 v182, v182, v222
    v_mul_f32 v183, v183, v222
    v_fma_f32 v182, v182, v102, v142
    v_fma_f32 v183, v183, v103, v143
    v_cvt_pk_bf16_f32 v225, v182, v183
    v_mul_f32 v184, v184, v222
    v_mul_f32 v185, v185, v222
    v_fma_f32 v184, v184, v104, v144
    v_fma_f32 v185, v185, v105, v145
    v_cvt_pk_bf16_f32 v226, v184, v185
    v_mul_f32 v186, v186, v222
    v_mul_f32 v187, v187, v222
    v_fma_f32 v186, v186, v106, v146
    v_fma_f32 v187, v187, v107, v147
    v_cvt_pk_bf16_f32 v227, v186, v187
    ds_write_b128 v7, v[224:227] offset:10368
    s_nop 1
    v_mul_f32 v188, v188, v222
    v_mul_f32 v189, v189, v222
    v_fma_f32 v188, v188, v108, v148
    v_fma_f32 v189, v189, v109, v149
    v_cvt_pk_bf16_f32 v224, v188, v189
    v_mul_f32 v190, v190, v222
    v_mul_f32 v191, v191, v222
    v_fma_f32 v190, v190, v110, v150
    v_fma_f32 v191, v191, v111, v151
    v_cvt_pk_bf16_f32 v225, v190, v191
    v_mul_f32 v192, v192, v222
    v_mul_f32 v193, v193, v222
    v_fma_f32 v192, v192, v112, v152
    v_fma_f32 v193, v193, v113, v153
    v_cvt_pk_bf16_f32 v226, v192, v193
    v_mul_f32 v194, v194, v222
    v_mul_f32 v195, v195, v222
    v_fma_f32 v194, v194, v114, v154
    v_fma_f32 v195, v195, v115, v155
    v_cvt_pk_bf16_f32 v227, v194, v195
    ds_write_b128 v7, v[224:227] offset:10624
    s_nop 1
    v_mul_f32 v196, v196, v222
    v_mul_f32 v197, v197, v222
    v_fma_f32 v196, v196, v116, v156
    v_fma_f32 v197, v197, v117, v157
    v_cvt_pk_bf16_f32 v224, v196, v197
    v_mul_f32 v198, v198, v222
    v_mul_f32 v199, v199, v222
    v_fma_f32 v198, v198, v118, v158
    v_fma_f32 v199, v199, v119, v159
    v_cvt_pk_bf16_f32 v225, v198, v199
    v_mul_f32 v200, v200, v222
    v_mul_f32 v201, v201, v222
    v_fma_f32 v200, v200, v120, v160
    v_fma_f32 v201, v201, v121, v161
    v_cvt_pk_bf16_f32 v226, v200, v201
    v_mul_f32 v202, v202, v222
    v_mul_f32 v203, v203, v222
    v_fma_f32 v202, v202, v122, v162
    v_fma_f32 v203, v203, v123, v163
    v_cvt_pk_bf16_f32 v227, v202, v203
    ds_write_b128 v7, v[224:227] offset:10880
    s_nop 1
    v_mul_f32 v204, v204, v222
    v_mul_f32 v205, v205, v222
    v_fma_f32 v204, v204, v124, v164
    v_fma_f32 v205, v205, v125, v165
    v_cvt_pk_bf16_f32 v224, v204, v205
    v_mul_f32 v206, v206, v222
    v_mul_f32 v207, v207, v222
    v_fma_f32 v206, v206, v126, v166
    v_fma_f32 v207, v207, v127, v167
    v_cvt_pk_bf16_f32 v225, v206, v207
    v_mul_f32 v208, v208, v222
    v_mul_f32 v209, v209, v222
    v_fma_f32 v208, v208, v128, v168
    v_fma_f32 v209, v209, v129, v169
    v_cvt_pk_bf16_f32 v226, v208, v209
    v_mul_f32 v210, v210, v222
    v_mul_f32 v211, v211, v222
    v_fma_f32 v210, v210, v130, v170
    v_fma_f32 v211, v211, v131, v171
    v_cvt_pk_bf16_f32 v227, v210, v211
    ds_write_b128 v7, v[224:227] offset:11136
    s_nop 1
    v_mul_f32 v212, v212, v222
    v_mul_f32 v213, v213, v222
    v_fma_f32 v212, v212, v132, v172
    v_fma_f32 v213, v213, v133, v173
    v_cvt_pk_bf16_f32 v224, v212, v213
    v_mul_f32 v214, v214, v222
    v_mul_f32 v215, v215, v222
    v_fma_f32 v214, v214, v134, v174
    v_fma_f32 v215, v215, v135, v175
    v_cvt_pk_bf16_f32 v225, v214, v215
    v_mul_f32 v216, v216, v222
    v_mul_f32 v217, v217, v222
    v_fma_f32 v216, v216, v136, v176
    v_fma_f32 v217, v217, v137, v177
    v_cvt_pk_bf16_f32 v226, v216, v217
    v_mul_f32 v218, v218, v222
    v_mul_f32 v219, v219, v222
    v_fma_f32 v218, v218, v138, v178
    v_fma_f32 v219, v219, v139, v179
    v_cvt_pk_bf16_f32 v227, v218, v219
    ds_write_b128 v7, v[224:227] offset:11392
    s_nop 1
    s_waitcnt vmcnt(0)
    v_mov_b32 v220, 0
    v_dot2c_f32_bf16 v220, s45, v80
    v_dot2c_f32_bf16 v220, s45, v81
    v_dot2c_f32_bf16 v220, s45, v82
    v_dot2c_f32_bf16 v220, s45, v83
    v_dot2c_f32_bf16 v220, s45, v84
    v_dot2c_f32_bf16 v220, s45, v85
    v_dot2c_f32_bf16 v220, s45, v86
    v_dot2c_f32_bf16 v220, s45, v87
    v_dot2c_f32_bf16 v220, s45, v88
    v_dot2c_f32_bf16 v220, s45, v89
    v_dot2c_f32_bf16 v220, s45, v90
    v_dot2c_f32_bf16 v220, s45, v91
    v_dot2c_f32_bf16 v220, s45, v92
    v_dot2c_f32_bf16 v220, s45, v93
    v_dot2c_f32_bf16 v220, s45, v94
    v_dot2c_f32_bf16 v220, s45, v95
    v_dot2c_f32_bf16 v220, s45, v96
    v_dot2c_f32_bf16 v220, s45, v97
    v_dot2c_f32_bf16 v220, s45, v98
    v_dot2c_f32_bf16 v220, s45, v99
    s_nop 1
    v_add_f32_dpp v220, v220, v220 row_ror:8 row_mask:0xf bank_mask:0xf
    s_nop 1
    v_add_f32_dpp v220, v220, v220 row_ror:4 row_mask:0xf bank_mask:0xf
    s_nop 1
    v_add_f32_dpp v220, v220, v220 row_ror:2 row_mask:0xf bank_mask:0xf
    s_nop 1
    v_add_f32_dpp v220, v220, v220 row_ror:1 row_mask:0xf bank_mask:0xf
    v_mul_f32 v220, s46, v220
    v_mov_b32 v221, 0
    v_lshlrev_b32 v180, 16, v80
    v_and_b32 v181, s44, v80
    v_sub_f32 v180, v180, v220
    v_sub_f32 v181, v181, v220
    v_fmac_f32 v221, v180, v180
    v_fmac_f32 v221, v181, v181
    v_lshlrev_b32 v182, 16, v81
    v_and_b32 v183, s44, v81
    v_sub_f32 v182, v182, v220
    v_sub_f32 v183, v183, v220
    v_fmac_f32 v221, v182, v182
    v_fmac_f32 v221, v183, v183
    v_lshlrev_b32 v184, 16, v82
    v_and_b32 v185, s44, v82
    v_sub_f32 v184, v184, v220
    v_sub_f32 v185, v185, v220
    v_fmac_f32 v221, v184, v184
    v_fmac_f32 v221, v185, v185
    v_lshlrev_b32 v186, 16, v83
    v_and_b32 v187, s44, v83
    v_sub_f32 v186, v186, v220
    v_sub_f32 v187, v187, v220
    v_fmac_f32 v221, v186, v186
    v_fmac_f32 v221, v187, v187
    v_lshlrev_b32 v188, 16, v84
    v_and_b32 v189, s44, v84
    v_sub_f32 v188, v188, v220
    v_sub_f32 v189, v189, v220
    v_fmac_f32 v221, v188, v188
    v_fmac_f32 v221, v189, v189
    v_lshlrev_b32 v190, 16, v85
    v_and_b32 v191, s44, v85
    v_sub_f32 v190, v190, v220
    v_sub_f32 v191, v191, v220
    v_fmac_f32 v221, v190, v190
    v_fmac_f32 v221, v191, v191
    v_lshlrev_b32 v192, 16, v86
    v_and_b32 v193, s44, v86
    v_sub_f32 v192, v192, v220
    v_sub_f32 v193, v193, v220
    v_fmac_f32 v221, v192, v192
    v_fmac_f32 v221, v193, v193
    v_lshlrev_b32 v194, 16, v87
    v_and_b32 v195, s44, v87
    v_sub_f32 v194, v194, v220
    v_sub_f32 v195, v195, v220
    v_fmac_f32 v221, v194, v194
    v_fmac_f32 v221, v195, v195
    v_lshlrev_b32 v196, 16, v88
    v_and_b32 v197, s44, v88
    v_sub_f32 v196, v196, v220
    v_sub_f32 v197, v197, v220
    v_fmac_f32 v221, v196, v196
    v_fmac_f32 v221, v197, v197
    v_lshlrev_b32 v198, 16, v89
    v_and_b32 v199, s44, v89
    v_sub_f32 v198, v198, v220
    v_sub_f32 v199, v199, v220
    v_fmac_f32 v221, v198, v198
    v_fmac_f32 v221, v199, v199
    v_lshlrev_b32 v200, 16, v90
    v_and_b32 v201, s44, v90
    v_sub_f32 v200, v200, v220
    v_sub_f32 v201, v201, v220
    v_fmac_f32 v221, v200, v200
    v_fmac_f32 v221, v201, v201
    v_lshlrev_b32 v202, 16, v91
    v_and_b32 v203, s44, v91
    v_sub_f32 v202, v202, v220
    v_sub_f32 v203, v203, v220
    v_fmac_f32 v221, v202, v202
    v_fmac_f32 v221, v203, v203
    v_lshlrev_b32 v204, 16, v92
    v_and_b32 v205, s44, v92
    v_sub_f32 v204, v204, v220
    v_sub_f32 v205, v205, v220
    v_fmac_f32 v221, v204, v204
    v_fmac_f32 v221, v205, v205
    v_lshlrev_b32 v206, 16, v93
    v_and_b32 v207, s44, v93
    v_sub_f32 v206, v206, v220
    v_sub_f32 v207, v207, v220
    v_fmac_f32 v221, v206, v206
    v_fmac_f32 v221, v207, v207
    v_lshlrev_b32 v208, 16, v94
    v_and_b32 v209, s44, v94
    v_sub_f32 v208, v208, v220
    v_sub_f32 v209, v209, v220
    v_fmac_f32 v221, v208, v208
    v_fmac_f32 v221, v209, v209
    v_lshlrev_b32 v210, 16, v95
    v_and_b32 v211, s44, v95
    v_sub_f32 v210, v210, v220
    v_sub_f32 v211, v211, v220
    v_fmac_f32 v221, v210, v210
    v_fmac_f32 v221, v211, v211
    v_lshlrev_b32 v212, 16, v96
    v_and_b32 v213, s44, v96
    v_sub_f32 v212, v212, v220
    v_sub_f32 v213, v213, v220
    v_fmac_f32 v221, v212, v212
    v_fmac_f32 v221, v213, v213
    v_lshlrev_b32 v214, 16, v97
    v_and_b32 v215, s44, v97
    v_sub_f32 v214, v214, v220
    v_sub_f32 v215, v215, v220
    v_fmac_f32 v221, v214, v214
    v_fmac_f32 v221, v215, v215
    v_lshlrev_b32 v216, 16, v98
    v_and_b32 v217, s44, v98
    v_sub_f32 v216, v216, v220
    v_sub_f32 v217, v217, v220
    v_fmac_f32 v221, v216, v216
    v_fmac_f32 v221, v217, v217
    v_lshlrev_b32 v218, 16, v99
    v_and_b32 v219, s44, v99
    v_sub_f32 v218, v218, v220
    v_sub_f32 v219, v219, v220
    v_fmac_f32 v221, v218, v218
    v_fmac_f32 v221, v219, v219
    s_nop 1
    v_add_f32_dpp v221, v221, v221 row_ror:8 row_mask:0xf bank_mask:0xf
    s_nop 1
    v_add_f32_dpp v221, v221, v221 row_ror:4 row_mask:0xf bank_mask:0xf
    s_nop 1
    v_add_f32_dpp v221, v221, v221 row_ror:2 row_mask:0xf bank_mask:0xf
    s_nop 1
    v_add_f32_dpp v221, v221, v221 row_ror:1 row_mask:0xf bank_mask:0xf
    v_mov_b32 v222, s47
    v_fmac_f32 v222, s46, v221
    v_rsq_f32 v222, v222
    s_nop 0
    v_mul_f32 v180, v180, v222
    v_mul_f32 v181, v181, v222
    v_fma_f32 v180, v180, v100, v140
    v_fma_f32 v181, v181, v101, v141
    v_cvt_pk_bf16_f32 v224, v180, v181
    v_mul_f32 v182, v182, v222
    v_mul_f32 v183, v183, v222
    v_fma_f32 v182, v182, v102, v142
    v_fma_f32 v183, v183, v103, v143
    v_cvt_pk_bf16_f32 v225, v182, v183
    v_mul_f32 v184, v184, v222
    v_mul_f32 v185, v185, v222
    v_fma_f32 v184, v184, v104, v144
    v_fma_f32 v185, v185, v105, v145
    v_cvt_pk_bf16_f32 v226, v184, v185
    v_mul_f32 v186, v186, v222
    v_mul_f32 v187, v187, v222
    v_fma_f32 v186, v186, v106, v146
    v_fma_f32 v187, v187, v107, v147
    v_cvt_pk_bf16_f32 v227, v186, v187
    ds_write_b128 v7, v[224:227] offset:15552
    s_nop 1
    v_mul_f32 v188, v188, v222
    v_mul_f32 v189, v189, v222
    v_fma_f32 v188, v188, v108, v148
    v_fma_f32 v189, v189, v109, v149
    v_cvt_pk_bf16_f32 v224, v188, v189
    v_mul_f32 v190, v190, v222
    v_mul_f32 v191, v191, v222
    v_fma_f32 v190, v190, v110, v150
    v_fma_f32 v191, v191, v111, v151
    v_cvt_pk_bf16_f32 v225, v190, v191
    v_mul_f32 v192, v192, v222
    v_mul_f32 v193, v193, v222
    v_fma_f32 v192, v192, v112, v152
    v_fma_f32 v193, v193, v113, v153
    v_cvt_pk_bf16_f32 v226, v192, v193
    v_mul_f32 v194, v194, v222
    v_mul_f32 v195, v195, v222
    v_fma_f32 v194, v194, v114, v154
    v_fma_f32 v195, v195, v115, v155
    v_cvt_pk_bf16_f32 v227, v194, v195
    ds_write_b128 v7, v[224:227] offset:15808
    s_nop 1
    v_mul_f32 v196, v196, v222
    v_mul_f32 v197, v197, v222
    v_fma_f32 v196, v196, v116, v156
    v_fma_f32 v197, v197, v117, v157
    v_cvt_pk_bf16_f32 v224, v196, v197
    v_mul_f32 v198, v198, v222
    v_mul_f32 v199, v199, v222
    v_fma_f32 v198, v198, v118, v158
    v_fma_f32 v199, v199, v119, v159
    v_cvt_pk_bf16_f32 v225, v198, v199
    v_mul_f32 v200, v200, v222
    v_mul_f32 v201, v201, v222
    v_fma_f32 v200, v200, v120, v160
    v_fma_f32 v201, v201, v121, v161
    v_cvt_pk_bf16_f32 v226, v200, v201
    v_mul_f32 v202, v202, v222
    v_mul_f32 v203, v203, v222
    v_fma_f32 v202, v202, v122, v162
    v_fma_f32 v203, v203, v123, v163
    v_cvt_pk_bf16_f32 v227, v202, v203
    ds_write_b128 v7, v[224:227] offset:16064
    s_nop 1
    v_mul_f32 v204, v204, v222
    v_mul_f32 v205, v205, v222
    v_fma_f32 v204, v204, v124, v164
    v_fma_f32 v205, v205, v125, v165
    v_cvt_pk_bf16_f32 v224, v204, v205
    v_mul_f32 v206, v206, v222
    v_mul_f32 v207, v207, v222
    v_fma_f32 v206, v206, v126, v166
    v_fma_f32 v207, v207, v127, v167
    v_cvt_pk_bf16_f32 v225, v206, v207
    v_mul_f32 v208, v208, v222
    v_mul_f32 v209, v209, v222
    v_fma_f32 v208, v208, v128, v168
    v_fma_f32 v209, v209, v129, v169
    v_cvt_pk_bf16_f32 v226, v208, v209
    v_mul_f32 v210, v210, v222
    v_mul_f32 v211, v211, v222
    v_fma_f32 v210, v210, v130, v170
    v_fma_f32 v211, v211, v131, v171
    v_cvt_pk_bf16_f32 v227, v210, v211
    ds_write_b128 v7, v[224:227] offset:16320
    s_nop 1
    v_mul_f32 v212, v212, v222
    v_mul_f32 v213, v213, v222
    v_fma_f32 v212, v212, v132, v172
    v_fma_f32 v213, v213, v133, v173
    v_cvt_pk_bf16_f32 v224, v212, v213
    v_mul_f32 v214, v214, v222
    v_mul_f32 v215, v215, v222
    v_fma_f32 v214, v214, v134, v174
    v_fma_f32 v215, v215, v135, v175
    v_cvt_pk_bf16_f32 v225, v214, v215
    v_mul_f32 v216, v216, v222
    v_mul_f32 v217, v217, v222
    v_fma_f32 v216, v216, v136, v176
    v_fma_f32 v217, v217, v137, v177
    v_cvt_pk_bf16_f32 v226, v216, v217
    v_mul_f32 v218, v218, v222
    v_mul_f32 v219, v219, v222
    v_fma_f32 v218, v218, v138, v178
    v_fma_f32 v219, v219, v139, v179
    v_cvt_pk_bf16_f32 v227, v218, v219
    ds_write_b128 v7, v[224:227] offset:16576
    s_nop 1
    s_waitcnt lgkmcnt(0)
    s_barrier
    v_lshrrev_b32 v3, 4, v1
    v_lshlrev_b32 v3, 2, v3
    v_and_b32 v4, 15, v1
    v_lshrrev_b32 v5, 2, v4
    v_add_u32 v3, v3, v5
    v_mul_u32_u24 v3, 160, v3
    v_and_b32 v5, 3, v4
    v_lshlrev_b32 v5, 3, v5
    v_add_u32 v3, v3, v5
    v_add_u32 v245, s42, v3
    v_mul_u32_u24 v3, 1296, v4
    v_lshrrev_b32 v5, 4, v1
    v_lshlrev_b32 v5, 4, v5
    v_add_u32 v246, v3, v5
    v_accvgpr_write_b32 a0, 0
    v_accvgpr_write_b32 a1, 0
    v_accvgpr_write_b32 a2, 0
    v_accvgpr_write_b32 a3, 0
    v_accvgpr_write_b32 a4, 0
    v_accvgpr_write_b32 a5, 0
    v_accvgpr_write_b32 a6, 0
    v_accvgpr_write_b32 a7, 0
    v_accvgpr_write_b32 a8, 0
    v_accvgpr_write_b32 a9, 0
    v_accvgpr_write_b32 a10, 0
    v_accvgpr_write_b32 a11, 0
    v_accvgpr_write_b32 a12, 0
    v_accvgpr_write_b32 a13, 0
    v_accvgpr_write_b32 a14, 0
    v_accvgpr_write_b32 a15, 0
    v_accvgpr_write_b32 a16, 0
    v_accvgpr_write_b32 a17, 0
    v_accvgpr_write_b32 a18, 0
    v_accvgpr_write_b32 a19, 0
    v_accvgpr_write_b32 a20, 0
    v_accvgpr_write_b32 a21, 0
    v_accvgpr_write_b32 a22, 0
    v_accvgpr_write_b32 a23, 0
    v_accvgpr_write_b32 a24, 0
    v_accvgpr_write_b32 a25, 0
    v_accvgpr_write_b32 a26, 0
    v_accvgpr_write_b32 a27, 0
    v_accvgpr_write_b32 a28, 0
    v_accvgpr_write_b32 a29, 0
    v_accvgpr_write_b32 a30, 0
    v_accvgpr_write_b32 a31, 0
    v_accvgpr_write_b32 a32, 0
    v_accvgpr_write_b32 a33, 0
    v_accvgpr_write_b32 a34, 0
    v_accvgpr_write_b32 a35, 0
    v_accvgpr_write_b32 a36, 0
    v_accvgpr_write_b32 a37, 0
    v_accvgpr_write_b32 a38, 0
    v_accvgpr_write_b32 a39, 0
    v_accvgpr_write_b32 a40, 0
    v_accvgpr_write_b32 a41, 0
    v_accvgpr_write_b32 a42, 0
    v_accvgpr_write_b32 a43, 0
    v_accvgpr_write_b32 a44, 0
    v_accvgpr_write_b32 a45, 0
    v_accvgpr_write_b32 a46, 0
    v_accvgpr_write_b32 a47, 0
    v_accvgpr_write_b32 a48, 0
    v_accvgpr_write_b32 a49, 0
    v_accvgpr_write_b32 a50, 0
    v_accvgpr_write_b32 a51, 0
    v_accvgpr_write_b32 a52, 0
    v_accvgpr_write_b32 a53, 0
    v_accvgpr_write_b32 a54, 0
    v_accvgpr_write_b32 a55, 0
    v_accvgpr_write_b32 a56, 0
    v_accvgpr_write_b32 a57, 0
    v_accvgpr_write_b32 a58, 0
    v_accvgpr_write_b32 a59, 0
    v_accvgpr_write_b32 a60, 0
    v_accvgpr_write_b32 a61, 0
    v_accvgpr_write_b32 a62, 0
    v_accvgpr_write_b32 a63, 0
    v_accvgpr_write_b32 a64, 0
    v_accvgpr_write_b32 a65, 0
    v_accvgpr_write_b32 a66, 0
    v_accvgpr_write_b32 a67, 0
    v_accvgpr_write_b32 a68, 0
    v_accvgpr_write_b32 a69, 0
    v_accvgpr_write_b32 a70, 0
    v_accvgpr_write_b32 a71, 0
    v_accvgpr_write_b32 a72, 0
    v_accvgpr_write_b32 a73, 0
    v_accvgpr_write_b32 a74, 0
    v_accvgpr_write_b32 a75, 0
    v_accvgpr_write_b32 a76, 0
    v_accvgpr_write_b32 a77, 0
    v_accvgpr_write_b32 a78, 0
    v_accvgpr_write_b32 a79, 0
    s_waitcnt vmcnt(5)
    ds_read_b64_tr_b16 v[20:21], v245 offset:0
    ds_read_b64_tr_b16 v[22:23], v245 offset:2560
    ds_read_b64_tr_b16 v[24:25], v245 offset:32
    ds_read_b64_tr_b16 v[26:27], v245 offset:2592
    ds_read_b64_tr_b16 v[28:29], v245 offset:64
    ds_read_b64_tr_b16 v[30:31], v245 offset:2624
    ds_read_b64_tr_b16 v[32:33], v245 offset:96
    ds_read_b64_tr_b16 v[34:35], v245 offset:2656
    ds_read_b64_tr_b16 v[36:37], v245 offset:128
    ds_read_b64_tr_b16 v[38:39], v245 offset:2688
    ds_read_b128 v[60:63], v246 offset:0
    ds_read_b128 v[64:67], v246 offset:20736
    ds_read_b128 v[68:71], v246 offset:41472
    ds_read_b128 v[72:75], v246 offset:62208
    s_waitcnt lgkmcnt(0)
    v_mfma_f32_16x16x32_bf16 a[0:3], v[20:23], v[60:63], a[0:3]
    s_mov_b32 s41, 81920
    s_add_u32 s43, s42, 10240
    s_mov_b32 m0, s43
    s_nop 0
    buffer_load_dwordx4 v240, s[28:31], s41 offen lds
    v_mfma_f32_16x16x32_bf16 a[4:7], v[20:23], v[64:67], a[4:7]
    s_add_u32 s43, s42, 11264
    s_mov_b32 m0, s43
    s_nop 0
    buffer_load_dwordx4 v241, s[28:31], s41 offen lds
    v_mfma_f32_16x16x32_bf16 a[8:11], v[20:23], v[68:71], a[8:11]
    s_add_u32 s43, s42, 12288
    s_mov_b32 m0, s43
    s_nop 0
    buffer_load_dwordx4 v242, s[28:31], s41 offen lds
    v_mfma_f32_16x16x32_bf16 a[12:15], v[20:23], v[72:75], a[12:15]
    s_add_u32 s43, s42, 13312
    s_mov_b32 m0, s43
    s_nop 0
    buffer_load_dwordx4 v243, s[28:31], s41 offen lds
    v_mfma_f32_16x16x32_bf16 a[16:19], v[24:27], v[60:63], a[16:19]
    s_add_u32 s43, s42, 14336
    s_mov_b32 m0, s43
    s_nop 0
    buffer_load_dwordx4 v244, s[28:31], s41 offen lds
    v_mfma_f32_16x16x32_bf16 a[20:23], v[24:27], v[64:67], a[20:23]
    s_waitcnt vmcnt(5)
    ds_read_b64_tr_b16 v[40:41], v245 offset:5120
    v_mfma_f32_16x16x32_bf16 a[24:27], v[24:27], v[68:71], a[24:27]
    ds_read_b64_tr_b16 v[42:43], v245 offset:7680
    v_mfma_f32_16x16x32_bf16 a[28:31], v[24:27], v[72:75], a[28:31]
    ds_read_b64_tr_b16 v[44:45], v245 offset:5152
    v_mfma_f32_16x16x32_bf16 a[32:35], v[28:31], v[60:63], a[32:35]
    ds_read_b64_tr_b16 v[46:47], v245 offset:7712
    v_mfma_f32_16x16x32_bf16 a[36:39], v[28:31], v[64:67], a[36:39]
    ds_read_b64_tr_b16 v[48:49], v245 offset:5184
    v_mfma_f32_16x16x32_bf16 a[40:43], v[28:31], v[68:71], a[40:43]
    ds_read_b64_tr_b16 v[50:51], v245 offset:7744
    v_mfma_f32_16x16x32_bf16 a[44:47], v[28:31], v[72:75], a[44:47]
    ds_read_b64_tr_b16 v[52:53], v245 offset:5216
    v_mfma_f32_16x16x32_bf16 a[48:51], v[32:35], v[60:63], a[48:51]
    ds_read_b64_tr_b16 v[54:55], v245 offset:7776
    v_mfma_f32_16x16x32_bf16 a[52:55], v[32:35], v[64:67], a[52:55]
    ds_read_b64_tr_b16 v[56:57], v245 offset:5248
    v_mfma_f32_16x16x32_bf16 a[56:59], v[32:35], v[68:71], a[56:59]
    ds_read_b64_tr_b16 v[58:59], v245 offset:7808
    v_mfma_f32_16x16x32_bf16 a[60:63], v[32:35], v[72:75], a[60:63]
    ds_read_b128 v[76:79], v246 offset:64
    v_mfma_f32_16x16x32_bf16 a[64:67], v[36:39], v[60:63], a[64:67]
    ds_read_b128 v[80:83], v246 offset:20800
    v_mfma_f32_16x16x32_bf16 a[68:71], v[36:39], v[64:67], a[68:71]
    ds_read_b128 v[84:87], v246 offset:41536
    v_mfma_f32_16x16x32_bf16 a[72:75], v[36:39], v[68:71], a[72:75]
    ds_read_b128 v[88:91], v246 offset:62272
    v_mfma_f32_16x16x32_bf16 a[76:79], v[36:39], v[72:75], a[76:79]
    s_waitcnt lgkmcnt(0)
    v_mfma_f32_16x16x32_bf16 a[0:3], v[40:43], v[76:79], a[0:3]
    s_mov_b32 s41, 122880
    s_add_u32 s43, s42, 0
    s_mov_b32 m0, s43
    s_nop 0
    buffer_load_dwordx4 v240, s[28:31], s41 offen lds
    v_mfma_f32_16x16x32_bf16 a[4:7], v[40:43], v[80:83], a[4:7]
    s_add_u32 s43, s42, 1024
    s_mov_b32 m0, s43
    s_nop 0
    buffer_load_dwordx4 v241, s[28:31], s41 offen lds
    v_mfma_f32_16x16x32_bf16 a[8:11], v[40:43], v[84:87], a[8:11]
    s_add_u32 s43, s42, 2048
    s_mov_b32 m0, s43
    s_nop 0
    buffer_load_dwordx4 v242, s[28:31], s41 offen lds
    v_mfma_f32_16x16x32_bf16 a[12:15], v[40:43], v[88:91], a[12:15]
    s_add_u32 s43, s42, 3072
    s_mov_b32 m0, s43
    s_nop 0
    buffer_load_dwordx4 v243, s[28:31], s41 offen lds
    v_mfma_f32_16x16x32_bf16 a[16:19], v[44:47], v[76:79], a[16:19]
    s_add_u32 s43, s42, 4096
    s_mov_b32 m0, s43
    s_nop 0
    buffer_load_dwordx4 v244, s[28:31], s41 offen lds
    v_mfma_f32_16x16x32_bf16 a[20:23], v[44:47], v[80:83], a[20:23]
    s_waitcnt vmcnt(5)
    ds_read_b64_tr_b16 v[20:21], v245 offset:10240
    v_mfma_f32_16x16x32_bf16 a[24:27], v[44:47], v[84:87], a[24:27]
    ds_read_b64_tr_b16 v[22:23], v245 offset:12800
    v_mfma_f32_16x16x32_bf16 a[28:31], v[44:47], v[88:91], a[28:31]
    ds_read_b64_tr_b16 v[24:25], v245 offset:10272
    v_mfma_f32_16x16x32_bf16 a[32:35], v[48:51], v[76:79], a[32:35]
    ds_read_b64_tr_b16 v[26:27], v245 offset:12832
    v_mfma_f32_16x16x32_bf16 a[36:39], v[48:51], v[80:83], a[36:39]
    ds_read_b64_tr_b16 v[28:29], v245 offset:10304
    v_mfma_f32_16x16x32_bf16 a[40:43], v[48:51], v[84:87], a[40:43]
    ds_read_b64_tr_b16 v[30:31], v245 offset:12864
    v_mfma_f32_16x16x32_bf16 a[44:47], v[48:51], v[88:91], a[44:47]
    ds_read_b64_tr_b16 v[32:33], v245 offset:10336
    v_mfma_f32_16x16x32_bf16 a[48:51], v[52:55], v[76:79], a[48:51]
    ds_read_b64_tr_b16 v[34:35], v245 offset:12896
    v_mfma_f32_16x16x32_bf16 a[52:55], v[52:55], v[80:83], a[52:55]
    ds_read_b64_tr_b16 v[36:37], v245 offset:10368
    v_mfma_f32_16x16x32_bf16 a[56:59], v[52:55], v[84:87], a[56:59]
    ds_read_b64_tr_b16 v[38:39], v245 offset:12928
    v_mfma_f32_16x16x32_bf16 a[60:63], v[52:55], v[88:91], a[60:63]
    ds_read_b128 v[60:63], v246 offset:128
    v_mfma_f32_16x16x32_bf16 a[64:67], v[56:59], v[76:79], a[64:67]
    ds_read_b128 v[64:67], v246 offset:20864
    v_mfma_f32_16x16x32_bf16 a[68:71], v[56:59], v[80:83], a[68:71]
    ds_read_b128 v[68:71], v246 offset:41600
    v_mfma_f32_16x16x32_bf16 a[72:75], v[56:59], v[84:87], a[72:75]
    ds_read_b128 v[72:75], v246 offset:62336
    v_mfma_f32_16x16x32_bf16 a[76:79], v[56:59], v[88:91], a[76:79]
    s_waitcnt lgkmcnt(0)
    v_mfma_f32_16x16x32_bf16 a[0:3], v[20:23], v[60:63], a[0:3]
    s_mov_b32 s41, 163840
    s_add_u32 s43, s42, 5120
    s_mov_b32 m0, s43
    s_nop 0
    buffer_load_dwordx4 v240, s[28:31], s41 offen lds
    v_mfma_f32_16x16x32_bf16 a[4:7], v[20:23], v[64:67], a[4:7]
    s_add_u32 s43, s42, 6144
    s_mov_b32 m0, s43
    s_nop 0
    buffer_load_dwordx4 v241, s[28:31], s41 offen lds
    v_mfma_f32_16x16x32_bf16 a[8:11], v[20:23], v[68:71], a[8:11]
    s_add_u32 s43, s42, 7168
    s_mov_b32 m0, s43
    s_nop 0
    buffer_load_dwordx4 v242, s[28:31], s41 offen lds
    v_mfma_f32_16x16x32_bf16 a[12:15], v[20:23], v[72:75], a[12:15]
    s_add_u32 s43, s42, 8192
    s_mov_b32 m0, s43
    s_nop 0
    buffer_load_dwordx4 v243, s[28:31], s41 offen lds
    v_mfma_f32_16x16x32_bf16 a[16:19], v[24:27], v[60:63], a[16:19]
    s_add_u32 s43, s42, 9216
    s_mov_b32 m0, s43
    s_nop 0
    buffer_load_dwordx4 v244, s[28:31], s41 offen lds
    v_mfma_f32_16x16x32_bf16 a[20:23], v[24:27], v[64:67], a[20:23]
    s_waitcnt vmcnt(5)
    ds_read_b64_tr_b16 v[40:41], v245 offset:0
    v_mfma_f32_16x16x32_bf16 a[24:27], v[24:27], v[68:71], a[24:27]
    ds_read_b64_tr_b16 v[42:43], v245 offset:2560
    v_mfma_f32_16x16x32_bf16 a[28:31], v[24:27], v[72:75], a[28:31]
    ds_read_b64_tr_b16 v[44:45], v245 offset:32
    v_mfma_f32_16x16x32_bf16 a[32:35], v[28:31], v[60:63], a[32:35]
    ds_read_b64_tr_b16 v[46:47], v245 offset:2592
    v_mfma_f32_16x16x32_bf16 a[36:39], v[28:31], v[64:67], a[36:39]
    ds_read_b64_tr_b16 v[48:49], v245 offset:64
    v_mfma_f32_16x16x32_bf16 a[40:43], v[28:31], v[68:71], a[40:43]
    ds_read_b64_tr_b16 v[50:51], v245 offset:2624
    v_mfma_f32_16x16x32_bf16 a[44:47], v[28:31], v[72:75], a[44:47]
    ds_read_b64_tr_b16 v[52:53], v245 offset:96
    v_mfma_f32_16x16x32_bf16 a[48:51], v[32:35], v[60:63], a[48:51]
    ds_read_b64_tr_b16 v[54:55], v245 offset:2656
    v_mfma_f32_16x16x32_bf16 a[52:55], v[32:35], v[64:67], a[52:55]
    ds_read_b64_tr_b16 v[56:57], v245 offset:128
    v_mfma_f32_16x16x32_bf16 a[56:59], v[32:35], v[68:71], a[56:59]
    ds_read_b64_tr_b16 v[58:59], v245 offset:2688
    v_mfma_f32_16x16x32_bf16 a[60:63], v[32:35], v[72:75], a[60:63]
    ds_read_b128 v[76:79], v246 offset:192
    v_mfma_f32_16x16x32_bf16 a[64:67], v[36:39], v[60:63], a[64:67]
    ds_read_b128 v[80:83], v246 offset:20928
    v_mfma_f32_16x16x32_bf16 a[68:71], v[36:39], v[64:67], a[68:71]
    ds_read_b128 v[84:87], v246 offset:41664
    v_mfma_f32_16x16x32_bf16 a[72:75], v[36:39], v[68:71], a[72:75]
    ds_read_b128 v[88:91], v246 offset:62400
    v_mfma_f32_16x16x32_bf16 a[76:79], v[36:39], v[72:75], a[76:79]
    s_waitcnt lgkmcnt(0)
    v_mfma_f32_16x16x32_bf16 a[0:3], v[40:43], v[76:79], a[0:3]
    s_mov_b32 s41, 204800
    s_add_u32 s43, s42, 10240
    s_mov_b32 m0, s43
    s_nop 0
    buffer_load_dwordx4 v240, s[28:31], s41 offen lds
    v_mfma_f32_16x16x32_bf16 a[4:7], v[40:43], v[80:83], a[4:7]
    s_add_u32 s43, s42, 11264
    s_mov_b32 m0, s43
    s_nop 0
    buffer_load_dwordx4 v241, s[28:31], s41 offen lds
    v_mfma_f32_16x16x32_bf16 a[8:11], v[40:43], v[84:87], a[8:11]
    s_add_u32 s43, s42, 12288
    s_mov_b32 m0, s43
    s_nop 0
    buffer_load_dwordx4 v242, s[28:31], s41 offen lds
    v_mfma_f32_16x16x32_bf16 a[12:15], v[40:43], v[88:91], a[12:15]
    s_add_u32 s43, s42, 13312
    s_mov_b32 m0, s43
    s_nop 0
    buffer_load_dwordx4 v243, s[28:31], s41 offen lds
    v_mfma_f32_16x16x32_bf16 a[16:19], v[44:47], v[76:79], a[16:19]
    s_add_u32 s43, s42, 14336
    s_mov_b32 m0, s43
    s_nop 0
    buffer_load_dwordx4 v244, s[28:31], s41 offen lds
    v_mfma_f32_16x16x32_bf16 a[20:23], v[44:47], v[80:83], a[20:23]
    s_waitcnt vmcnt(5)
    ds_read_b64_tr_b16 v[20:21], v245 offset:5120
    v_mfma_f32_16x16x32_bf16 a[24:27], v[44:47], v[84:87], a[24:27]
    ds_read_b64_tr_b16 v[22:23], v245 offset:7680
    v_mfma_f32_16x16x32_bf16 a[28:31], v[44:47], v[88:91], a[28:31]
    ds_read_b64_tr_b16 v[24:25], v245 offset:5152
    v_mfma_f32_16x16x32_bf16 a[32:35], v[48:51], v[76:79], a[32:35]
    ds_read_b64_tr_b16 v[26:27], v245 offset:7712
    v_mfma_f32_16x16x32_bf16 a[36:39], v[48:51], v[80:83], a[36:39]
    ds_read_b64_tr_b16 v[28:29], v245 offset:5184
    v_mfma_f32_16x16x32_bf16 a[40:43], v[48:51], v[84:87], a[40:43]
    ds_read_b64_tr_b16 v[30:31], v245 offset:7744
    v_mfma_f32_16x16x32_bf16 a[44:47], v[48:51], v[88:91], a[44:47]
    ds_read_b64_tr_b16 v[32:33], v245 offset:5216
    v_mfma_f32_16x16x32_bf16 a[48:51], v[52:55], v[76:79], a[48:51]
    ds_read_b64_tr_b16 v[34:35], v245 offset:7776
    v_mfma_f32_16x16x32_bf16 a[52:55], v[52:55], v[80:83], a[52:55]
    ds_read_b64_tr_b16 v[36:37], v245 offset:5248
    v_mfma_f32_16x16x32_bf16 a[56:59], v[52:55], v[84:87], a[56:59]
    ds_read_b64_tr_b16 v[38:39], v245 offset:7808
    v_mfma_f32_16x16x32_bf16 a[60:63], v[52:55], v[88:91], a[60:63]
    ds_read_b128 v[60:63], v246 offset:256
    v_mfma_f32_16x16x32_bf16 a[64:67], v[56:59], v[76:79], a[64:67]
    ds_read_b128 v[64:67], v246 offset:20992
    v_mfma_f32_16x16x32_bf16 a[68:71], v[56:59], v[80:83], a[68:71]
    ds_read_b128 v[68:71], v246 offset:41728
    v_mfma_f32_16x16x32_bf16 a[72:75], v[56:59], v[84:87], a[72:75]
    ds_read_b128 v[72:75], v246 offset:62464
    v_mfma_f32_16x16x32_bf16 a[76:79], v[56:59], v[88:91], a[76:79]
    s_waitcnt lgkmcnt(0)
    v_mfma_f32_16x16x32_bf16 a[0:3], v[20:23], v[60:63], a[0:3]
    s_mov_b32 s41, 245760
    s_add_u32 s43, s42, 0
    s_mov_b32 m0, s43
    s_nop 0
    buffer_load_dwordx4 v240, s[28:31], s41 offen lds
    v_mfma_f32_16x16x32_bf16 a[4:7], v[20:23], v[64:67], a[4:7]
    s_add_u32 s43, s42, 1024
    s_mov_b32 m0, s43
    s_nop 0
    buffer_load_dwordx4 v241, s[28:31], s41 offen lds
    v_mfma_f32_16x16x32_bf16 a[8:11], v[20:23], v[68:71], a[8:11]
    s_add_u32 s43, s42, 2048
    s_mov_b32 m0, s43
    s_nop 0
    buffer_load_dwordx4 v242, s[28:31], s41 offen lds
    v_mfma_f32_16x16x32_bf16 a[12:15], v[20:23], v[72:75], a[12:15]
    s_add_u32 s43, s42, 3072
    s_mov_b32 m0, s43
    s_nop 0
    buffer_load_dwordx4 v243, s[28:31], s41 offen lds
    v_mfma_f32_16x16x32_bf16 a[16:19], v[24:27], v[60:63], a[16:19]
    s_add_u32 s43, s42, 4096
    s_mov_b32 m0, s43
    s_nop 0
    buffer_load_dwordx4 v244, s[28:31], s41 offen lds
    v_mfma_f32_16x16x32_bf16 a[20:23], v[24:27], v[64:67], a[20:23]
    s_waitcnt vmcnt(5)
    ds_read_b64_tr_b16 v[40:41], v245 offset:10240
    v_mfma_f32_16x16x32_bf16 a[24:27], v[24:27], v[68:71], a[24:27]
    ds_read_b64_tr_b16 v[42:43], v245 offset:12800
    v_mfma_f32_16x16x32_bf16 a[28:31], v[24:27], v[72:75], a[28:31]
    ds_read_b64_tr_b16 v[44:45], v245 offset:10272
    v_mfma_f32_16x16x32_bf16 a[32:35], v[28:31], v[60:63], a[32:35]
    ds_read_b64_tr_b16 v[46:47], v245 offset:12832
    v_mfma_f32_16x16x32_bf16 a[36:39], v[28:31], v[64:67], a[36:39]
    ds_read_b64_tr_b16 v[48:49], v245 offset:10304
    v_mfma_f32_16x16x32_bf16 a[40:43], v[28:31], v[68:71], a[40:43]
    ds_read_b64_tr_b16 v[50:51], v245 offset:12864
    v_mfma_f32_16x16x32_bf16 a[44:47], v[28:31], v[72:75], a[44:47]
    ds_read_b64_tr_b16 v[52:53], v245 offset:10336
    v_mfma_f32_16x16x32_bf16 a[48:51], v[32:35], v[60:63], a[48:51]
    ds_read_b64_tr_b16 v[54:55], v245 offset:12896
    v_mfma_f32_16x16x32_bf16 a[52:55], v[32:35], v[64:67], a[52:55]
    ds_read_b64_tr_b16 v[56:57], v245 offset:10368
    v_mfma_f32_16x16x32_bf16 a[56:59], v[32:35], v[68:71], a[56:59]
    ds_read_b64_tr_b16 v[58:59], v245 offset:12928
    v_mfma_f32_16x16x32_bf16 a[60:63], v[32:35], v[72:75], a[60:63]
    ds_read_b128 v[76:79], v246 offset:320
    v_mfma_f32_16x16x32_bf16 a[64:67], v[36:39], v[60:63], a[64:67]
    ds_read_b128 v[80:83], v246 offset:21056
    v_mfma_f32_16x16x32_bf16 a[68:71], v[36:39], v[64:67], a[68:71]
    ds_read_b128 v[84:87], v246 offset:41792
    v_mfma_f32_16x16x32_bf16 a[72:75], v[36:39], v[68:71], a[72:75]
    ds_read_b128 v[88:91], v246 offset:62528
    v_mfma_f32_16x16x32_bf16 a[76:79], v[36:39], v[72:75], a[76:79]
    s_waitcnt lgkmcnt(0)
    v_mfma_f32_16x16x32_bf16 a[0:3], v[40:43], v[76:79], a[0:3]
    s_mov_b32 s41, 286720
    s_add_u32 s43, s42, 5120
    s_mov_b32 m0, s43
    s_nop 0
    buffer_load_dwordx4 v240, s[28:31], s41 offen lds
    v_mfma_f32_16x16x32_bf16 a[4:7], v[40:43], v[80:83], a[4:7]
    s_add_u32 s43, s42, 6144
    s_mov_b32 m0, s43
    s_nop 0
    buffer_load_dwordx4 v241, s[28:31], s41 offen lds
    v_mfma_f32_16x16x32_bf16 a[8:11], v[40:43], v[84:87], a[8:11]
    s_add_u32 s43, s42, 7168
    s_mov_b32 m0, s43
    s_nop 0
    buffer_load_dwordx4 v242, s[28:31], s41 offen lds
    v_mfma_f32_16x16x32_bf16 a[12:15], v[40:43], v[88:91], a[12:15]
    s_add_u32 s43, s42, 8192
    s_mov_b32 m0, s43
    s_nop 0
    buffer_load_dwordx4 v243, s[28:31], s41 offen lds
    v_mfma_f32_16x16x32_bf16 a[16:19], v[44:47], v[76:79], a[16:19]
    s_add_u32 s43, s42, 9216
    s_mov_b32 m0, s43
    s_nop 0
    buffer_load_dwordx4 v244, s[28:31], s41 offen lds
    v_mfma_f32_16x16x32_bf16 a[20:23], v[44:47], v[80:83], a[20:23]
    s_waitcnt vmcnt(5)
    ds_read_b64_tr_b16 v[20:21], v245 offset:0
    v_mfma_f32_16x16x32_bf16 a[24:27], v[44:47], v[84:87], a[24:27]
    ds_read_b64_tr_b16 v[22:23], v245 offset:2560
    v_mfma_f32_16x16x32_bf16 a[28:31], v[44:47], v[88:91], a[28:31]
    ds_read_b64_tr_b16 v[24:25], v245 offset:32
    v_mfma_f32_16x16x32_bf16 a[32:35], v[48:51], v[76:79], a[32:35]
    ds_read_b64_tr_b16 v[26:27], v245 offset:2592
    v_mfma_f32_16x16x32_bf16 a[36:39], v[48:51], v[80:83], a[36:39]
    ds_read_b64_tr_b16 v[28:29], v245 offset:64
    v_mfma_f32_16x16x32_bf16 a[40:43], v[48:51], v[84:87], a[40:43]
    ds_read_b64_tr_b16 v[30:31], v245 offset:2624
    v_mfma_f32_16x16x32_bf16 a[44:47], v[48:51], v[88:91], a[44:47]
    ds_read_b64_tr_b16 v[32:33], v245 offset:96
    v_mfma_f32_16x16x32_bf16 a[48:51], v[52:55], v[76:79], a[48:51]
    ds_read_b64_tr_b16 v[34:35], v245 offset:2656
    v_mfma_f32_16x16x32_bf16 a[52:55], v[52:55], v[80:83], a[52:55]
    ds_read_b64_tr_b16 v[36:37], v245 offset:128
    v_mfma_f32_16x16x32_bf16 a[56:59], v[52:55], v[84:87], a[56:59]
    ds_read_b64_tr_b16 v[38:39], v245 offset:2688
    v_mfma_f32_16x16x32_bf16 a[60:63], v[52:55], v[88:91], a[60:63]
    ds_read_b128 v[60:63], v246 offset:384
    v_mfma_f32_16x16x32_bf16 a[64:67], v[56:59], v[76:79], a[64:67]
    ds_read_b128 v[64:67], v246 offset:21120
    v_mfma_f32_16x16x32_bf16 a[68:71], v[56:59], v[80:83], a[68:71]
    ds_read_b128 v[68:71], v246 offset:41856
    v_mfma_f32_16x16x32_bf16 a[72:75], v[56:59], v[84:87], a[72:75]
    ds_read_b128 v[72:75], v246 offset:62592
    v_mfma_f32_16x16x32_bf16 a[76:79], v[56:59], v[88:91], a[76:79]
    s_waitcnt lgkmcnt(0)
    v_mfma_f32_16x16x32_bf16 a[0:3], v[20:23], v[60:63], a[0:3]
    s_mov_b32 s41, 327680
    s_add_u32 s43, s42, 10240
    s_mov_b32 m0, s43
    s_nop 0
    buffer_load_dwordx4 v240, s[28:31], s41 offen lds
    v_mfma_f32_16x16x32_bf16 a[4:7], v[20:23], v[64:67], a[4:7]
    s_add_u32 s43, s42, 11264
    s_mov_b32 m0, s43
    s_nop 0
    buffer_load_dwordx4 v241, s[28:31], s41 offen lds
    v_mfma_f32_16x16x32_bf16 a[8:11], v[20:23], v[68:71], a[8:11]
    s_add_u32 s43, s42, 12288
    s_mov_b32 m0, s43
    s_nop 0
    buffer_load_dwordx4 v242, s[28:31], s41 offen lds
    v_mfma_f32_16x16x32_bf16 a[12:15], v[20:23], v[72:75], a[12:15]
    s_add_u32 s43, s42, 13312
    s_mov_b32 m0, s43
    s_nop 0
    buffer_load_dwordx4 v243, s[28:31], s41 offen lds
    v_mfma_f32_16x16x32_bf16 a[16:19], v[24:27], v[60:63], a[16:19]
    s_add_u32 s43, s42, 14336
    s_mov_b32 m0, s43
    s_nop 0
    buffer_load_dwordx4 v244, s[28:31], s41 offen lds
    v_mfma_f32_16x16x32_bf16 a[20:23], v[24:27], v[64:67], a[20:23]
    s_waitcnt vmcnt(5)
    ds_read_b64_tr_b16 v[40:41], v245 offset:5120
    v_mfma_f32_16x16x32_bf16 a[24:27], v[24:27], v[68:71], a[24:27]
    ds_read_b64_tr_b16 v[42:43], v245 offset:7680
    v_mfma_f32_16x16x32_bf16 a[28:31], v[24:27], v[72:75], a[28:31]
    ds_read_b64_tr_b16 v[44:45], v245 offset:5152
    v_mfma_f32_16x16x32_bf16 a[32:35], v[28:31], v[60:63], a[32:35]
    ds_read_b64_tr_b16 v[46:47], v245 offset:7712
    v_mfma_f32_16x16x32_bf16 a[36:39], v[28:31], v[64:67], a[36:39]
    ds_read_b64_tr_b16 v[48:49], v245 offset:5184
    v_mfma_f32_16x16x32_bf16 a[40:43], v[28:31], v[68:71], a[40:43]
    ds_read_b64_tr_b16 v[50:51], v245 offset:7744
    v_mfma_f32_16x16x32_bf16 a[44:47], v[28:31], v[72:75], a[44:47]
    ds_read_b64_tr_b16 v[52:53], v245 offset:5216
    v_mfma_f32_16x16x32_bf16 a[48:51], v[32:35], v[60:63], a[48:51]
    ds_read_b64_tr_b16 v[54:55], v245 offset:7776
    v_mfma_f32_16x16x32_bf16 a[52:55], v[32:35], v[64:67], a[52:55]
    ds_read_b64_tr_b16 v[56:57], v245 offset:5248
    v_mfma_f32_16x16x32_bf16 a[56:59], v[32:35], v[68:71], a[56:59]
    ds_read_b64_tr_b16 v[58:59], v245 offset:7808
    v_mfma_f32_16x16x32_bf16 a[60:63], v[32:35], v[72:75], a[60:63]
    ds_read_b128 v[76:79], v246 offset:448
    v_mfma_f32_16x16x32_bf16 a[64:67], v[36:39], v[60:63], a[64:67]
    ds_read_b128 v[80:83], v246 offset:21184
    v_mfma_f32_16x16x32_bf16 a[68:71], v[36:39], v[64:67], a[68:71]
    ds_read_b128 v[84:87], v246 offset:41920
    v_mfma_f32_16x16x32_bf16 a[72:75], v[36:39], v[68:71], a[72:75]
    ds_read_b128 v[88:91], v246 offset:62656
    v_mfma_f32_16x16x32_bf16 a[76:79], v[36:39], v[72:75], a[76:79]
    s_waitcnt lgkmcnt(0)
    v_mfma_f32_16x16x32_bf16 a[0:3], v[40:43], v[76:79], a[0:3]
    s_mov_b32 s41, 368640
    s_add_u32 s43, s42, 0
    s_mov_b32 m0, s43
    s_nop 0
    buffer_load_dwordx4 v240, s[28:31], s41 offen lds
    v_mfma_f32_16x16x32_bf16 a[4:7], v[40:43], v[80:83], a[4:7]
    s_add_u32 s43, s42, 1024
    s_mov_b32 m0, s43
    s_nop 0
    buffer_load_dwordx4 v241, s[28:31], s41 offen lds
    v_mfma_f32_16x16x32_bf16 a[8:11], v[40:43], v[84:87], a[8:11]
    s_add_u32 s43, s42, 2048
    s_mov_b32 m0, s43
    s_nop 0
    buffer_load_dwordx4 v242, s[28:31], s41 offen lds
    v_mfma_f32_16x16x32_bf16 a[12:15], v[40:43], v[88:91], a[12:15]
    s_add_u32 s43, s42, 3072
    s_mov_b32 m0, s43
    s_nop 0
    buffer_load_dwordx4 v243, s[28:31], s41 offen lds
    v_mfma_f32_16x16x32_bf16 a[16:19], v[44:47], v[76:79], a[16:19]
    s_add_u32 s43, s42, 4096
    s_mov_b32 m0, s43
    s_nop 0
    buffer_load_dwordx4 v244, s[28:31], s41 offen lds
    v_mfma_f32_16x16x32_bf16 a[20:23], v[44:47], v[80:83], a[20:23]
    s_waitcnt vmcnt(5)
    ds_read_b64_tr_b16 v[20:21], v245 offset:10240
    v_mfma_f32_16x16x32_bf16 a[24:27], v[44:47], v[84:87], a[24:27]
    ds_read_b64_tr_b16 v[22:23], v245 offset:12800
    v_mfma_f32_16x16x32_bf16 a[28:31], v[44:47], v[88:91], a[28:31]
    ds_read_b64_tr_b16 v[24:25], v245 offset:10272
    v_mfma_f32_16x16x32_bf16 a[32:35], v[48:51], v[76:79], a[32:35]
    ds_read_b64_tr_b16 v[26:27], v245 offset:12832
    v_mfma_f32_16x16x32_bf16 a[36:39], v[48:51], v[80:83], a[36:39]
    ds_read_b64_tr_b16 v[28:29], v245 offset:10304
    v_mfma_f32_16x16x32_bf16 a[40:43], v[48:51], v[84:87], a[40:43]
    ds_read_b64_tr_b16 v[30:31], v245 offset:12864
    v_mfma_f32_16x16x32_bf16 a[44:47], v[48:51], v[88:91], a[44:47]
    ds_read_b64_tr_b16 v[32:33], v245 offset:10336
    v_mfma_f32_16x16x32_bf16 a[48:51], v[52:55], v[76:79], a[48:51]
    ds_read_b64_tr_b16 v[34:35], v245 offset:12896
    v_mfma_f32_16x16x32_bf16 a[52:55], v[52:55], v[80:83], a[52:55]
    ds_read_b64_tr_b16 v[36:37], v245 offset:10368
    v_mfma_f32_16x16x32_bf16 a[56:59], v[52:55], v[84:87], a[56:59]
    ds_read_b64_tr_b16 v[38:39], v245 offset:12928
    v_mfma_f32_16x16x32_bf16 a[60:63], v[52:55], v[88:91], a[60:63]
    ds_read_b128 v[60:63], v246 offset:512
    v_mfma_f32_16x16x32_bf16 a[64:67], v[56:59], v[76:79], a[64:67]
    ds_read_b128 v[64:67], v246 offset:21248
    v_mfma_f32_16x16x32_bf16 a[68:71], v[56:59], v[80:83], a[68:71]
    ds_read_b128 v[68:71], v246 offset:41984
    v_mfma_f32_16x16x32_bf16 a[72:75], v[56:59], v[84:87], a[72:75]
    ds_read_b128 v[72:75], v246 offset:62720
    v_mfma_f32_16x16x32_bf16 a[76:79], v[56:59], v[88:91], a[76:79]
    s_waitcnt lgkmcnt(0)
    v_mfma_f32_16x16x32_bf16 a[0:3], v[20:23], v[60:63], a[0:3]
    s_mov_b32 s41, 409600
    s_add_u32 s43, s42, 5120
    s_mov_b32 m0, s43
    s_nop 0
    buffer_load_dwordx4 v240, s[28:31], s41 offen lds
    v_mfma_f32_16x16x32_bf16 a[4:7], v[20:23], v[64:67], a[4:7]
    s_add_u32 s43, s42, 6144
    s_mov_b32 m0, s43
    s_nop 0
    buffer_load_dwordx4 v241, s[28:31], s41 offen lds
    v_mfma_f32_16x16x32_bf16 a[8:11], v[20:23], v[68:71], a[8:11]
    s_add_u32 s43, s42, 7168
    s_mov_b32 m0, s43
    s_nop 0
    buffer_load_dwordx4 v242, s[28:31], s41 offen lds
    v_mfma_f32_16x16x32_bf16 a[12:15], v[20:23], v[72:75], a[12:15]
    s_add_u32 s43, s42, 8192
    s_mov_b32 m0, s43
    s_nop 0
    buffer_load_dwordx4 v243, s[28:31], s41 offen lds
    v_mfma_f32_16x16x32_bf16 a[16:19], v[24:27], v[60:63], a[16:19]
    s_add_u32 s43, s42, 9216
    s_mov_b32 m0, s43
    s_nop 0
    buffer_load_dwordx4 v244, s[28:31], s41 offen lds
    v_mfma_f32_16x16x32_bf16 a[20:23], v[24:27], v[64:67], a[20:23]
    s_waitcnt vmcnt(5)
    ds_read_b64_tr_b16 v[40:41], v245 offset:0
    v_mfma_f32_16x16x32_bf16 a[24:27], v[24:27], v[68:71], a[24:27]
    ds_read_b64_tr_b16 v[42:43], v245 offset:2560
    v_mfma_f32_16x16x32_bf16 a[28:31], v[24:27], v[72:75], a[28:31]
    ds_read_b64_tr_b16 v[44:45], v245 offset:32
    v_mfma_f32_16x16x32_bf16 a[32:35], v[28:31], v[60:63], a[32:35]
    ds_read_b64_tr_b16 v[46:47], v245 offset:2592
    v_mfma_f32_16x16x32_bf16 a[36:39], v[28:31], v[64:67], a[36:39]
    ds_read_b64_tr_b16 v[48:49], v245 offset:64
    v_mfma_f32_16x16x32_bf16 a[40:43], v[28:31], v[68:71], a[40:43]
    ds_read_b64_tr_b16 v[50:51], v245 offset:2624
    v_mfma_f32_16x16x32_bf16 a[44:47], v[28:31], v[72:75], a[44:47]
    ds_read_b64_tr_b16 v[52:53], v245 offset:96
    v_mfma_f32_16x16x32_bf16 a[48:51], v[32:35], v[60:63], a[48:51]
    ds_read_b64_tr_b16 v[54:55], v245 offset:2656
    v_mfma_f32_16x16x32_bf16 a[52:55], v[32:35], v[64:67], a[52:55]
    ds_read_b64_tr_b16 v[56:57], v245 offset:128
    v_mfma_f32_16x16x32_bf16 a[56:59], v[32:35], v[68:71], a[56:59]
    ds_read_b64_tr_b16 v[58:59], v245 offset:2688
    v_mfma_f32_16x16x32_bf16 a[60:63], v[32:35], v[72:75], a[60:63]
    ds_read_b128 v[76:79], v246 offset:576
    v_mfma_f32_16x16x32_bf16 a[64:67], v[36:39], v[60:63], a[64:67]
    ds_read_b128 v[80:83], v246 offset:21312
    v_mfma_f32_16x16x32_bf16 a[68:71], v[36:39], v[64:67], a[68:71]
    ds_read_b128 v[84:87], v246 offset:42048
    v_mfma_f32_16x16x32_bf16 a[72:75], v[36:39], v[68:71], a[72:75]
    ds_read_b128 v[88:91], v246 offset:62784
    v_mfma_f32_16x16x32_bf16 a[76:79], v[36:39], v[72:75], a[76:79]
    s_waitcnt lgkmcnt(0)
    v_mfma_f32_16x16x32_bf16 a[0:3], v[40:43], v[76:79], a[0:3]
    s_mov_b32 s41, 450560
    s_add_u32 s43, s42, 10240
    s_mov_b32 m0, s43
    s_nop 0
    buffer_load_dwordx4 v240, s[28:31], s41 offen lds
    v_mfma_f32_16x16x32_bf16 a[4:7], v[40:43], v[80:83], a[4:7]
    s_add_u32 s43, s42, 11264
    s_mov_b32 m0, s43
    s_nop 0
    buffer_load_dwordx4 v241, s[28:31], s41 offen lds
    v_mfma_f32_16x16x32_bf16 a[8:11], v[40:43], v[84:87], a[8:11]
    s_add_u32 s43, s42, 12288
    s_mov_b32 m0, s43
    s_nop 0
    buffer_load_dwordx4 v242, s[28:31], s41 offen lds
    v_mfma_f32_16x16x32_bf16 a[12:15], v[40:43], v[88:91], a[12:15]
    s_add_u32 s43, s42, 13312
    s_mov_b32 m0, s43
    s_nop 0
    buffer_load_dwordx4 v243, s[28:31], s41 offen lds
    v_mfma_f32_16x16x32_bf16 a[16:19], v[44:47], v[76:79], a[16:19]
    s_add_u32 s43, s42, 14336
    s_mov_b32 m0, s43
    s_nop 0
    buffer_load_dwordx4 v244, s[28:31], s41 offen lds
    v_mfma_f32_16x16x32_bf16 a[20:23], v[44:47], v[80:83], a[20:23]
    s_waitcnt vmcnt(5)
    ds_read_b64_tr_b16 v[20:21], v245 offset:5120
    v_mfma_f32_16x16x32_bf16 a[24:27], v[44:47], v[84:87], a[24:27]
    ds_read_b64_tr_b16 v[22:23], v245 offset:7680
    v_mfma_f32_16x16x32_bf16 a[28:31], v[44:47], v[88:91], a[28:31]
    ds_read_b64_tr_b16 v[24:25], v245 offset:5152
    v_mfma_f32_16x16x32_bf16 a[32:35], v[48:51], v[76:79], a[32:35]
    ds_read_b64_tr_b16 v[26:27], v245 offset:7712
    v_mfma_f32_16x16x32_bf16 a[36:39], v[48:51], v[80:83], a[36:39]
    ds_read_b64_tr_b16 v[28:29], v245 offset:5184
    v_mfma_f32_16x16x32_bf16 a[40:43], v[48:51], v[84:87], a[40:43]
    ds_read_b64_tr_b16 v[30:31], v245 offset:7744
    v_mfma_f32_16x16x32_bf16 a[44:47], v[48:51], v[88:91], a[44:47]
    ds_read_b64_tr_b16 v[32:33], v245 offset:5216
    v_mfma_f32_16x16x32_bf16 a[48:51], v[52:55], v[76:79], a[48:51]
    ds_read_b64_tr_b16 v[34:35], v245 offset:7776
    v_mfma_f32_16x16x32_bf16 a[52:55], v[52:55], v[80:83], a[52:55]
    ds_read_b64_tr_b16 v[36:37], v245 offset:5248
    v_mfma_f32_16x16x32_bf16 a[56:59], v[52:55], v[84:87], a[56:59]
    ds_read_b64_tr_b16 v[38:39], v245 offset:7808
    v_mfma_f32_16x16x32_bf16 a[60:63], v[52:55], v[88:91], a[60:63]
    ds_read_b128 v[60:63], v246 offset:640
    v_mfma_f32_16x16x32_bf16 a[64:67], v[56:59], v[76:79], a[64:67]
    ds_read_b128 v[64:67], v246 offset:21376
    v_mfma_f32_16x16x32_bf16 a[68:71], v[56:59], v[80:83], a[68:71]
    ds_read_b128 v[68:71], v246 offset:42112
    v_mfma_f32_16x16x32_bf16 a[72:75], v[56:59], v[84:87], a[72:75]
    ds_read_b128 v[72:75], v246 offset:62848
    v_mfma_f32_16x16x32_bf16 a[76:79], v[56:59], v[88:91], a[76:79]
    s_waitcnt lgkmcnt(0)
    v_mfma_f32_16x16x32_bf16 a[0:3], v[20:23], v[60:63], a[0:3]
    s_mov_b32 s41, 491520
    s_add_u32 s43, s42, 0
    s_mov_b32 m0, s43
    s_nop 0
    buffer_load_dwordx4 v240, s[28:31], s41 offen lds
    v_mfma_f32_16x16x32_bf16 a[4:7], v[20:23], v[64:67], a[4:7]
    s_add_u32 s43, s42, 1024
    s_mov_b32 m0, s43
    s_nop 0
    buffer_load_dwordx4 v241, s[28:31], s41 offen lds
    v_mfma_f32_16x16x32_bf16 a[8:11], v[20:23], v[68:71], a[8:11]
    s_add_u32 s43, s42, 2048
    s_mov_b32 m0, s43
    s_nop 0
    buffer_load_dwordx4 v242, s[28:31], s41 offen lds
    v_mfma_f32_16x16x32_bf16 a[12:15], v[20:23], v[72:75], a[12:15]
    s_add_u32 s43, s42, 3072
    s_mov_b32 m0, s43
    s_nop 0
    buffer_load_dwordx4 v243, s[28:31], s41 offen lds
    v_mfma_f32_16x16x32_bf16 a[16:19], v[24:27], v[60:63], a[16:19]
    s_add_u32 s43, s42, 4096
    s_mov_b32 m0, s43
    s_nop 0
    buffer_load_dwordx4 v244, s[28:31], s41 offen lds
    v_mfma_f32_16x16x32_bf16 a[20:23], v[24:27], v[64:67], a[20:23]
    s_waitcnt vmcnt(5)
    ds_read_b64_tr_b16 v[40:41], v245 offset:10240
    v_mfma_f32_16x16x32_bf16 a[24:27], v[24:27], v[68:71], a[24:27]
    ds_read_b64_tr_b16 v[42:43], v245 offset:12800
    v_mfma_f32_16x16x32_bf16 a[28:31], v[24:27], v[72:75], a[28:31]
    ds_read_b64_tr_b16 v[44:45], v245 offset:10272
    v_mfma_f32_16x16x32_bf16 a[32:35], v[28:31], v[60:63], a[32:35]
    ds_read_b64_tr_b16 v[46:47], v245 offset:12832
    v_mfma_f32_16x16x32_bf16 a[36:39], v[28:31], v[64:67], a[36:39]
    ds_read_b64_tr_b16 v[48:49], v245 offset:10304
    v_mfma_f32_16x16x32_bf16 a[40:43], v[28:31], v[68:71], a[40:43]
    ds_read_b64_tr_b16 v[50:51], v245 offset:12864
    v_mfma_f32_16x16x32_bf16 a[44:47], v[28:31], v[72:75], a[44:47]
    ds_read_b64_tr_b16 v[52:53], v245 offset:10336
    v_mfma_f32_16x16x32_bf16 a[48:51], v[32:35], v[60:63], a[48:51]
    ds_read_b64_tr_b16 v[54:55], v245 offset:12896
    v_mfma_f32_16x16x32_bf16 a[52:55], v[32:35], v[64:67], a[52:55]
    ds_read_b64_tr_b16 v[56:57], v245 offset:10368
    v_mfma_f32_16x16x32_bf16 a[56:59], v[32:35], v[68:71], a[56:59]
    ds_read_b64_tr_b16 v[58:59], v245 offset:12928
    v_mfma_f32_16x16x32_bf16 a[60:63], v[32:35], v[72:75], a[60:63]
    ds_read_b128 v[76:79], v246 offset:704
    v_mfma_f32_16x16x32_bf16 a[64:67], v[36:39], v[60:63], a[64:67]
    ds_read_b128 v[80:83], v246 offset:21440
    v_mfma_f32_16x16x32_bf16 a[68:71], v[36:39], v[64:67], a[68:71]
    ds_read_b128 v[84:87], v246 offset:42176
    v_mfma_f32_16x16x32_bf16 a[72:75], v[36:39], v[68:71], a[72:75]
    ds_read_b128 v[88:91], v246 offset:62912
    v_mfma_f32_16x16x32_bf16 a[76:79], v[36:39], v[72:75], a[76:79]
    s_waitcnt lgkmcnt(0)
    v_mfma_f32_16x16x32_bf16 a[0:3], v[40:43], v[76:79], a[0:3]
    s_mov_b32 s41, 532480
    s_add_u32 s43, s42, 5120
    s_mov_b32 m0, s43
    s_nop 0
    buffer_load_dwordx4 v240, s[28:31], s41 offen lds
    v_mfma_f32_16x16x32_bf16 a[4:7], v[40:43], v[80:83], a[4:7]
    s_add_u32 s43, s42, 6144
    s_mov_b32 m0, s43
    s_nop 0
    buffer_load_dwordx4 v241, s[28:31], s41 offen lds
    v_mfma_f32_16x16x32_bf16 a[8:11], v[40:43], v[84:87], a[8:11]
    s_add_u32 s43, s42, 7168
    s_mov_b32 m0, s43
    s_nop 0
    buffer_load_dwordx4 v242, s[28:31], s41 offen lds
    v_mfma_f32_16x16x32_bf16 a[12:15], v[40:43], v[88:91], a[12:15]
    s_add_u32 s43, s42, 8192
    s_mov_b32 m0, s43
    s_nop 0
    buffer_load_dwordx4 v243, s[28:31], s41 offen lds
    v_mfma_f32_16x16x32_bf16 a[16:19], v[44:47], v[76:79], a[16:19]
    s_add_u32 s43, s42, 9216
    s_mov_b32 m0, s43
    s_nop 0
    buffer_load_dwordx4 v244, s[28:31], s41 offen lds
    v_mfma_f32_16x16x32_bf16 a[20:23], v[44:47], v[80:83], a[20:23]
    s_waitcnt vmcnt(5)
    ds_read_b64_tr_b16 v[20:21], v245 offset:0
    v_mfma_f32_16x16x32_bf16 a[24:27], v[44:47], v[84:87], a[24:27]
    ds_read_b64_tr_b16 v[22:23], v245 offset:2560
    v_mfma_f32_16x16x32_bf16 a[28:31], v[44:47], v[88:91], a[28:31]
    ds_read_b64_tr_b16 v[24:25], v245 offset:32
    v_mfma_f32_16x16x32_bf16 a[32:35], v[48:51], v[76:79], a[32:35]
    ds_read_b64_tr_b16 v[26:27], v245 offset:2592
    v_mfma_f32_16x16x32_bf16 a[36:39], v[48:51], v[80:83], a[36:39]
    ds_read_b64_tr_b16 v[28:29], v245 offset:64
    v_mfma_f32_16x16x32_bf16 a[40:43], v[48:51], v[84:87], a[40:43]
    ds_read_b64_tr_b16 v[30:31], v245 offset:2624
    v_mfma_f32_16x16x32_bf16 a[44:47], v[48:51], v[88:91], a[44:47]
    ds_read_b64_tr_b16 v[32:33], v245 offset:96
    v_mfma_f32_16x16x32_bf16 a[48:51], v[52:55], v[76:79], a[48:51]
    ds_read_b64_tr_b16 v[34:35], v245 offset:2656
    v_mfma_f32_16x16x32_bf16 a[52:55], v[52:55], v[80:83], a[52:55]
    ds_read_b64_tr_b16 v[36:37], v245 offset:128
    v_mfma_f32_16x16x32_bf16 a[56:59], v[52:55], v[84:87], a[56:59]
    ds_read_b64_tr_b16 v[38:39], v245 offset:2688
    v_mfma_f32_16x16x32_bf16 a[60:63], v[52:55], v[88:91], a[60:63]
    ds_read_b128 v[60:63], v246 offset:768
    v_mfma_f32_16x16x32_bf16 a[64:67], v[56:59], v[76:79], a[64:67]
    ds_read_b128 v[64:67], v246 offset:21504
    v_mfma_f32_16x16x32_bf16 a[68:71], v[56:59], v[80:83], a[68:71]
    ds_read_b128 v[68:71], v246 offset:42240
    v_mfma_f32_16x16x32_bf16 a[72:75], v[56:59], v[84:87], a[72:75]
    ds_read_b128 v[72:75], v246 offset:62976
    v_mfma_f32_16x16x32_bf16 a[76:79], v[56:59], v[88:91], a[76:79]
    s_waitcnt lgkmcnt(0)
    v_mfma_f32_16x16x32_bf16 a[0:3], v[20:23], v[60:63], a[0:3]
    s_mov_b32 s41, 573440
    s_add_u32 s43, s42, 10240
    s_mov_b32 m0, s43
    s_nop 0
    buffer_load_dwordx4 v240, s[28:31], s41 offen lds
    v_mfma_f32_16x16x32_bf16 a[4:7], v[20:23], v[64:67], a[4:7]
    s_add_u32 s43, s42, 11264
    s_mov_b32 m0, s43
    s_nop 0
    buffer_load_dwordx4 v241, s[28:31], s41 offen lds
    v_mfma_f32_16x16x32_bf16 a[8:11], v[20:23], v[68:71], a[8:11]
    s_add_u32 s43, s42, 12288
    s_mov_b32 m0, s43
    s_nop 0
    buffer_load_dwordx4 v242, s[28:31], s41 offen lds
    v_mfma_f32_16x16x32_bf16 a[12:15], v[20:23], v[72:75], a[12:15]
    s_add_u32 s43, s42, 13312
    s_mov_b32 m0, s43
    s_nop 0
    buffer_load_dwordx4 v243, s[28:31], s41 offen lds
    v_mfma_f32_16x16x32_bf16 a[16:19], v[24:27], v[60:63], a[16:19]
    s_add_u32 s43, s42, 14336
    s_mov_b32 m0, s43
    s_nop 0
    buffer_load_dwordx4 v244, s[28:31], s41 offen lds
    v_mfma_f32_16x16x32_bf16 a[20:23], v[24:27], v[64:67], a[20:23]
    s_waitcnt vmcnt(5)
    ds_read_b64_tr_b16 v[40:41], v245 offset:5120
    v_mfma_f32_16x16x32_bf16 a[24:27], v[24:27], v[68:71], a[24:27]
    ds_read_b64_tr_b16 v[42:43], v245 offset:7680
    v_mfma_f32_16x16x32_bf16 a[28:31], v[24:27], v[72:75], a[28:31]
    ds_read_b64_tr_b16 v[44:45], v245 offset:5152
    v_mfma_f32_16x16x32_bf16 a[32:35], v[28:31], v[60:63], a[32:35]
    ds_read_b64_tr_b16 v[46:47], v245 offset:7712
    v_mfma_f32_16x16x32_bf16 a[36:39], v[28:31], v[64:67], a[36:39]
    ds_read_b64_tr_b16 v[48:49], v245 offset:5184
    v_mfma_f32_16x16x32_bf16 a[40:43], v[28:31], v[68:71], a[40:43]
    ds_read_b64_tr_b16 v[50:51], v245 offset:7744
    v_mfma_f32_16x16x32_bf16 a[44:47], v[28:31], v[72:75], a[44:47]
    ds_read_b64_tr_b16 v[52:53], v245 offset:5216
    v_mfma_f32_16x16x32_bf16 a[48:51], v[32:35], v[60:63], a[48:51]
    ds_read_b64_tr_b16 v[54:55], v245 offset:7776
    v_mfma_f32_16x16x32_bf16 a[52:55], v[32:35], v[64:67], a[52:55]
    ds_read_b64_tr_b16 v[56:57], v245 offset:5248
    v_mfma_f32_16x16x32_bf16 a[56:59], v[32:35], v[68:71], a[56:59]
    ds_read_b64_tr_b16 v[58:59], v245 offset:7808
    v_mfma_f32_16x16x32_bf16 a[60:63], v[32:35], v[72:75], a[60:63]
    ds_read_b128 v[76:79], v246 offset:832
    v_mfma_f32_16x16x32_bf16 a[64:67], v[36:39], v[60:63], a[64:67]
    ds_read_b128 v[80:83], v246 offset:21568
    v_mfma_f32_16x16x32_bf16 a[68:71], v[36:39], v[64:67], a[68:71]
    ds_read_b128 v[84:87], v246 offset:42304
    v_mfma_f32_16x16x32_bf16 a[72:75], v[36:39], v[68:71], a[72:75]
    ds_read_b128 v[88:91], v246 offset:63040
    v_mfma_f32_16x16x32_bf16 a[76:79], v[36:39], v[72:75], a[76:79]
    s_waitcnt lgkmcnt(0)
    v_mfma_f32_16x16x32_bf16 a[0:3], v[40:43], v[76:79], a[0:3]
    s_mov_b32 s41, 614400
    s_add_u32 s43, s42, 0
    s_mov_b32 m0, s43
    s_nop 0
    buffer_load_dwordx4 v240, s[28:31], s41 offen lds
    v_mfma_f32_16x16x32_bf16 a[4:7], v[40:43], v[80:83], a[4:7]
    s_add_u32 s43, s42, 1024
    s_mov_b32 m0, s43
    s_nop 0
    buffer_load_dwordx4 v241, s[28:31], s41 offen lds
    v_mfma_f32_16x16x32_bf16 a[8:11], v[40:43], v[84:87], a[8:11]
    s_add_u32 s43, s42, 2048
    s_mov_b32 m0, s43
    s_nop 0
    buffer_load_dwordx4 v242, s[28:31], s41 offen lds
    v_mfma_f32_16x16x32_bf16 a[12:15], v[40:43], v[88:91], a[12:15]
    s_add_u32 s43, s42, 3072
    s_mov_b32 m0, s43
    s_nop 0
    buffer_load_dwordx4 v243, s[28:31], s41 offen lds
    v_mfma_f32_16x16x32_bf16 a[16:19], v[44:47], v[76:79], a[16:19]
    s_add_u32 s43, s42, 4096
    s_mov_b32 m0, s43
    s_nop 0
    buffer_load_dwordx4 v244, s[28:31], s41 offen lds
    v_mfma_f32_16x16x32_bf16 a[20:23], v[44:47], v[80:83], a[20:23]
    s_waitcnt vmcnt(5)
    ds_read_b64_tr_b16 v[20:21], v245 offset:10240
    v_mfma_f32_16x16x32_bf16 a[24:27], v[44:47], v[84:87], a[24:27]
    ds_read_b64_tr_b16 v[22:23], v245 offset:12800
    v_mfma_f32_16x16x32_bf16 a[28:31], v[44:47], v[88:91], a[28:31]
    ds_read_b64_tr_b16 v[24:25], v245 offset:10272
    v_mfma_f32_16x16x32_bf16 a[32:35], v[48:51], v[76:79], a[32:35]
    ds_read_b64_tr_b16 v[26:27], v245 offset:12832
    v_mfma_f32_16x16x32_bf16 a[36:39], v[48:51], v[80:83], a[36:39]
    ds_read_b64_tr_b16 v[28:29], v245 offset:10304
    v_mfma_f32_16x16x32_bf16 a[40:43], v[48:51], v[84:87], a[40:43]
    ds_read_b64_tr_b16 v[30:31], v245 offset:12864
    v_mfma_f32_16x16x32_bf16 a[44:47], v[48:51], v[88:91], a[44:47]
    ds_read_b64_tr_b16 v[32:33], v245 offset:10336
    v_mfma_f32_16x16x32_bf16 a[48:51], v[52:55], v[76:79], a[48:51]
    ds_read_b64_tr_b16 v[34:35], v245 offset:12896
    v_mfma_f32_16x16x32_bf16 a[52:55], v[52:55], v[80:83], a[52:55]
    ds_read_b64_tr_b16 v[36:37], v245 offset:10368
    v_mfma_f32_16x16x32_bf16 a[56:59], v[52:55], v[84:87], a[56:59]
    ds_read_b64_tr_b16 v[38:39], v245 offset:12928
    v_mfma_f32_16x16x32_bf16 a[60:63], v[52:55], v[88:91], a[60:63]
    ds_read_b128 v[60:63], v246 offset:896
    v_mfma_f32_16x16x32_bf16 a[64:67], v[56:59], v[76:79], a[64:67]
    ds_read_b128 v[64:67], v246 offset:21632
    v_mfma_f32_16x16x32_bf16 a[68:71], v[56:59], v[80:83], a[68:71]
    ds_read_b128 v[68:71], v246 offset:42368
    v_mfma_f32_16x16x32_bf16 a[72:75], v[56:59], v[84:87], a[72:75]
    ds_read_b128 v[72:75], v246 offset:63104
    v_mfma_f32_16x16x32_bf16 a[76:79], v[56:59], v[88:91], a[76:79]
    s_waitcnt lgkmcnt(0)
    v_mfma_f32_16x16x32_bf16 a[0:3], v[20:23], v[60:63], a[0:3]
    s_mov_b32 s41, 655360
    s_add_u32 s43, s42, 5120
    s_mov_b32 m0, s43
    s_nop 0
    buffer_load_dwordx4 v240, s[28:31], s41 offen lds
    v_mfma_f32_16x16x32_bf16 a[4:7], v[20:23], v[64:67], a[4:7]
    s_add_u32 s43, s42, 6144
    s_mov_b32 m0, s43
    s_nop 0
    buffer_load_dwordx4 v241, s[28:31], s41 offen lds
    v_mfma_f32_16x16x32_bf16 a[8:11], v[20:23], v[68:71], a[8:11]
    s_add_u32 s43, s42, 7168
    s_mov_b32 m0, s43
    s_nop 0
    buffer_load_dwordx4 v242, s[28:31], s41 offen lds
    v_mfma_f32_16x16x32_bf16 a[12:15], v[20:23], v[72:75], a[12:15]
    s_add_u32 s43, s42, 8192
    s_mov_b32 m0, s43
    s_nop 0
    buffer_load_dwordx4 v243, s[28:31], s41 offen lds
    v_mfma_f32_16x16x32_bf16 a[16:19], v[24:27], v[60:63], a[16:19]
    s_add_u32 s43, s42, 9216
    s_mov_b32 m0, s43
    s_nop 0
    buffer_load_dwordx4 v244, s[28:31], s41 offen lds
    v_mfma_f32_16x16x32_bf16 a[20:23], v[24:27], v[64:67], a[20:23]
    s_waitcnt vmcnt(5)
    ds_read_b64_tr_b16 v[40:41], v245 offset:0
    v_mfma_f32_16x16x32_bf16 a[24:27], v[24:27], v[68:71], a[24:27]
    ds_read_b64_tr_b16 v[42:43], v245 offset:2560
    v_mfma_f32_16x16x32_bf16 a[28:31], v[24:27], v[72:75], a[28:31]
    ds_read_b64_tr_b16 v[44:45], v245 offset:32
    v_mfma_f32_16x16x32_bf16 a[32:35], v[28:31], v[60:63], a[32:35]
    ds_read_b64_tr_b16 v[46:47], v245 offset:2592
    v_mfma_f32_16x16x32_bf16 a[36:39], v[28:31], v[64:67], a[36:39]
    ds_read_b64_tr_b16 v[48:49], v245 offset:64
    v_mfma_f32_16x16x32_bf16 a[40:43], v[28:31], v[68:71], a[40:43]
    ds_read_b64_tr_b16 v[50:51], v245 offset:2624
    v_mfma_f32_16x16x32_bf16 a[44:47], v[28:31], v[72:75], a[44:47]
    ds_read_b64_tr_b16 v[52:53], v245 offset:96
    v_mfma_f32_16x16x32_bf16 a[48:51], v[32:35], v[60:63], a[48:51]
    ds_read_b64_tr_b16 v[54:55], v245 offset:2656
    v_mfma_f32_16x16x32_bf16 a[52:55], v[32:35], v[64:67], a[52:55]
    ds_read_b64_tr_b16 v[56:57], v245 offset:128
    v_mfma_f32_16x16x32_bf16 a[56:59], v[32:35], v[68:71], a[56:59]
    ds_read_b64_tr_b16 v[58:59], v245 offset:2688
    v_mfma_f32_16x16x32_bf16 a[60:63], v[32:35], v[72:75], a[60:63]
    ds_read_b128 v[76:79], v246 offset:960
    v_mfma_f32_16x16x32_bf16 a[64:67], v[36:39], v[60:63], a[64:67]
    ds_read_b128 v[80:83], v246 offset:21696
    v_mfma_f32_16x16x32_bf16 a[68:71], v[36:39], v[64:67], a[68:71]
    ds_read_b128 v[84:87], v246 offset:42432
    v_mfma_f32_16x16x32_bf16 a[72:75], v[36:39], v[68:71], a[72:75]
    ds_read_b128 v[88:91], v246 offset:63168
    v_mfma_f32_16x16x32_bf16 a[76:79], v[36:39], v[72:75], a[76:79]
    s_waitcnt lgkmcnt(0)
    v_mfma_f32_16x16x32_bf16 a[0:3], v[40:43], v[76:79], a[0:3]
    s_mov_b32 s41, 696320
    s_add_u32 s43, s42, 10240
    s_mov_b32 m0, s43
    s_nop 0
    buffer_load_dwordx4 v240, s[28:31], s41 offen lds
    v_mfma_f32_16x16x32_bf16 a[4:7], v[40:43], v[80:83], a[4:7]
    s_add_u32 s43, s42, 11264
    s_mov_b32 m0, s43
    s_nop 0
    buffer_load_dwordx4 v241, s[28:31], s41 offen lds
    v_mfma_f32_16x16x32_bf16 a[8:11], v[40:43], v[84:87], a[8:11]
    s_add_u32 s43, s42, 12288
    s_mov_b32 m0, s43
    s_nop 0
    buffer_load_dwordx4 v242, s[28:31], s41 offen lds
    v_mfma_f32_16x16x32_bf16 a[12:15], v[40:43], v[88:91], a[12:15]
    s_add_u32 s43, s42, 13312
    s_mov_b32 m0, s43
    s_nop 0
    buffer_load_dwordx4 v243, s[28:31], s41 offen lds
    v_mfma_f32_16x16x32_bf16 a[16:19], v[44:47], v[76:79], a[16:19]
    s_add_u32 s43, s42, 14336
    s_mov_b32 m0, s43
    s_nop 0
    buffer_load_dwordx4 v244, s[28:31], s41 offen lds
    v_mfma_f32_16x16x32_bf16 a[20:23], v[44:47], v[80:83], a[20:23]
    s_waitcnt vmcnt(5)
    ds_read_b64_tr_b16 v[20:21], v245 offset:5120
    v_mfma_f32_16x16x32_bf16 a[24:27], v[44:47], v[84:87], a[24:27]
    ds_read_b64_tr_b16 v[22:23], v245 offset:7680
    v_mfma_f32_16x16x32_bf16 a[28:31], v[44:47], v[88:91], a[28:31]
    ds_read_b64_tr_b16 v[24:25], v245 offset:5152
    v_mfma_f32_16x16x32_bf16 a[32:35], v[48:51], v[76:79], a[32:35]
    ds_read_b64_tr_b16 v[26:27], v245 offset:7712
    v_mfma_f32_16x16x32_bf16 a[36:39], v[48:51], v[80:83], a[36:39]
    ds_read_b64_tr_b16 v[28:29], v245 offset:5184
    v_mfma_f32_16x16x32_bf16 a[40:43], v[48:51], v[84:87], a[40:43]
    ds_read_b64_tr_b16 v[30:31], v245 offset:7744
    v_mfma_f32_16x16x32_bf16 a[44:47], v[48:51], v[88:91], a[44:47]
    ds_read_b64_tr_b16 v[32:33], v245 offset:5216
    v_mfma_f32_16x16x32_bf16 a[48:51], v[52:55], v[76:79], a[48:51]
    ds_read_b64_tr_b16 v[34:35], v245 offset:7776
    v_mfma_f32_16x16x32_bf16 a[52:55], v[52:55], v[80:83], a[52:55]
    ds_read_b64_tr_b16 v[36:37], v245 offset:5248
    v_mfma_f32_16x16x32_bf16 a[56:59], v[52:55], v[84:87], a[56:59]
    ds_read_b64_tr_b16 v[38:39], v245 offset:7808
    v_mfma_f32_16x16x32_bf16 a[60:63], v[52:55], v[88:91], a[60:63]
    ds_read_b128 v[60:63], v246 offset:1024
    v_mfma_f32_16x16x32_bf16 a[64:67], v[56:59], v[76:79], a[64:67]
    ds_read_b128 v[64:67], v246 offset:21760
    v_mfma_f32_16x16x32_bf16 a[68:71], v[56:59], v[80:83], a[68:71]
    ds_read_b128 v[68:71], v246 offset:42496
    v_mfma_f32_16x16x32_bf16 a[72:75], v[56:59], v[84:87], a[72:75]
    ds_read_b128 v[72:75], v246 offset:63232
    v_mfma_f32_16x16x32_bf16 a[76:79], v[56:59], v[88:91], a[76:79]
    s_waitcnt lgkmcnt(0)
    v_mfma_f32_16x16x32_bf16 a[0:3], v[20:23], v[60:63], a[0:3]
    s_mov_b32 s41, 737280
    s_add_u32 s43, s42, 0
    s_mov_b32 m0, s43
    s_nop 0
    buffer_load_dwordx4 v240, s[28:31], s41 offen lds
    v_mfma_f32_16x16x32_bf16 a[4:7], v[20:23], v[64:67], a[4:7]
    s_add_u32 s43, s42, 1024
    s_mov_b32 m0, s43
    s_nop 0
    buffer_load_dwordx4 v241, s[28:31], s41 offen lds
    v_mfma_f32_16x16x32_bf16 a[8:11], v[20:23], v[68:71], a[8:11]
    s_add_u32 s43, s42, 2048
    s_mov_b32 m0, s43
    s_nop 0
    buffer_load_dwordx4 v242, s[28:31], s41 offen lds
    v_mfma_f32_16x16x32_bf16 a[12:15], v[20:23], v[72:75], a[12:15]
    s_add_u32 s43, s42, 3072
    s_mov_b32 m0, s43
    s_nop 0
    buffer_load_dwordx4 v243, s[28:31], s41 offen lds
    v_mfma_f32_16x16x32_bf16 a[16:19], v[24:27], v[60:63], a[16:19]
    s_add_u32 s43, s42, 4096
    s_mov_b32 m0, s43
    s_nop 0
    buffer_load_dwordx4 v244, s[28:31], s41 offen lds
    v_mfma_f32_16x16x32_bf16 a[20:23], v[24:27], v[64:67], a[20:23]
    s_waitcnt vmcnt(5)
    ds_read_b64_tr_b16 v[40:41], v245 offset:10240
    v_mfma_f32_16x16x32_bf16 a[24:27], v[24:27], v[68:71], a[24:27]
    ds_read_b64_tr_b16 v[42:43], v245 offset:12800
    v_mfma_f32_16x16x32_bf16 a[28:31], v[24:27], v[72:75], a[28:31]
    ds_read_b64_tr_b16 v[44:45], v245 offset:10272
    v_mfma_f32_16x16x32_bf16 a[32:35], v[28:31], v[60:63], a[32:35]
    ds_read_b64_tr_b16 v[46:47], v245 offset:12832
    v_mfma_f32_16x16x32_bf16 a[36:39], v[28:31], v[64:67], a[36:39]
    ds_read_b64_tr_b16 v[48:49], v245 offset:10304
    v_mfma_f32_16x16x32_bf16 a[40:43], v[28:31], v[68:71], a[40:43]
    ds_read_b64_tr_b16 v[50:51], v245 offset:12864
    v_mfma_f32_16x16x32_bf16 a[44:47], v[28:31], v[72:75], a[44:47]
    ds_read_b64_tr_b16 v[52:53], v245 offset:10336
    v_mfma_f32_16x16x32_bf16 a[48:51], v[32:35], v[60:63], a[48:51]
    ds_read_b64_tr_b16 v[54:55], v245 offset:12896
    v_mfma_f32_16x16x32_bf16 a[52:55], v[32:35], v[64:67], a[52:55]
    ds_read_b64_tr_b16 v[56:57], v245 offset:10368
    v_mfma_f32_16x16x32_bf16 a[56:59], v[32:35], v[68:71], a[56:59]
    ds_read_b64_tr_b16 v[58:59], v245 offset:12928
    v_mfma_f32_16x16x32_bf16 a[60:63], v[32:35], v[72:75], a[60:63]
    ds_read_b128 v[76:79], v246 offset:1088
    v_mfma_f32_16x16x32_bf16 a[64:67], v[36:39], v[60:63], a[64:67]
    ds_read_b128 v[80:83], v246 offset:21824
    v_mfma_f32_16x16x32_bf16 a[68:71], v[36:39], v[64:67], a[68:71]
    ds_read_b128 v[84:87], v246 offset:42560
    v_mfma_f32_16x16x32_bf16 a[72:75], v[36:39], v[68:71], a[72:75]
    ds_read_b128 v[88:91], v246 offset:63296
    v_mfma_f32_16x16x32_bf16 a[76:79], v[36:39], v[72:75], a[76:79]
    s_waitcnt lgkmcnt(0)
    v_mfma_f32_16x16x32_bf16 a[0:3], v[40:43], v[76:79], a[0:3]
    s_mov_b32 s41, 778240
    s_add_u32 s43, s42, 5120
    s_mov_b32 m0, s43
    s_nop 0
    buffer_load_dwordx4 v240, s[28:31], s41 offen lds
    v_mfma_f32_16x16x32_bf16 a[4:7], v[40:43], v[80:83], a[4:7]
    s_add_u32 s43, s42, 6144
    s_mov_b32 m0, s43
    s_nop 0
    buffer_load_dwordx4 v241, s[28:31], s41 offen lds
    v_mfma_f32_16x16x32_bf16 a[8:11], v[40:43], v[84:87], a[8:11]
    s_add_u32 s43, s42, 7168
    s_mov_b32 m0, s43
    s_nop 0
    buffer_load_dwordx4 v242, s[28:31], s41 offen lds
    v_mfma_f32_16x16x32_bf16 a[12:15], v[40:43], v[88:91], a[12:15]
    s_add_u32 s43, s42, 8192
    s_mov_b32 m0, s43
    s_nop 0
    buffer_load_dwordx4 v243, s[28:31], s41 offen lds
    v_mfma_f32_16x16x32_bf16 a[16:19], v[44:47], v[76:79], a[16:19]
    s_add_u32 s43, s42, 9216
    s_mov_b32 m0, s43
    s_nop 0
    buffer_load_dwordx4 v244, s[28:31], s41 offen lds
    v_mfma_f32_16x16x32_bf16 a[20:23], v[44:47], v[80:83], a[20:23]
    s_waitcnt vmcnt(5)
    ds_read_b64_tr_b16 v[20:21], v245 offset:0
    v_mfma_f32_16x16x32_bf16 a[24:27], v[44:47], v[84:87], a[24:27]
    ds_read_b64_tr_b16 v[22:23], v245 offset:2560
    v_mfma_f32_16x16x32_bf16 a[28:31], v[44:47], v[88:91], a[28:31]
    ds_read_b64_tr_b16 v[24:25], v245 offset:32
    v_mfma_f32_16x16x32_bf16 a[32:35], v[48:51], v[76:79], a[32:35]
    ds_read_b64_tr_b16 v[26:27], v245 offset:2592
    v_mfma_f32_16x16x32_bf16 a[36:39], v[48:51], v[80:83], a[36:39]
    ds_read_b64_tr_b16 v[28:29], v245 offset:64
    v_mfma_f32_16x16x32_bf16 a[40:43], v[48:51], v[84:87], a[40:43]
    ds_read_b64_tr_b16 v[30:31], v245 offset:2624
    v_mfma_f32_16x16x32_bf16 a[44:47], v[48:51], v[88:91], a[44:47]
    ds_read_b64_tr_b16 v[32:33], v245 offset:96
    v_mfma_f32_16x16x32_bf16 a[48:51], v[52:55], v[76:79], a[48:51]
    ds_read_b64_tr_b16 v[34:35], v245 offset:2656
    v_mfma_f32_16x16x32_bf16 a[52:55], v[52:55], v[80:83], a[52:55]
    ds_read_b64_tr_b16 v[36:37], v245 offset:128
    v_mfma_f32_16x16x32_bf16 a[56:59], v[52:55], v[84:87], a[56:59]
    ds_read_b64_tr_b16 v[38:39], v245 offset:2688
    v_mfma_f32_16x16x32_bf16 a[60:63], v[52:55], v[88:91], a[60:63]
    ds_read_b128 v[60:63], v246 offset:1152
    v_mfma_f32_16x16x32_bf16 a[64:67], v[56:59], v[76:79], a[64:67]
    ds_read_b128 v[64:67], v246 offset:21888
    v_mfma_f32_16x16x32_bf16 a[68:71], v[56:59], v[80:83], a[68:71]
    ds_read_b128 v[68:71], v246 offset:42624
    v_mfma_f32_16x16x32_bf16 a[72:75], v[56:59], v[84:87], a[72:75]
    ds_read_b128 v[72:75], v246 offset:63360
    v_mfma_f32_16x16x32_bf16 a[76:79], v[56:59], v[88:91], a[76:79]
    s_waitcnt lgkmcnt(0)
    v_mfma_f32_16x16x32_bf16 a[0:3], v[20:23], v[60:63], a[0:3]
    v_mfma_f32_16x16x32_bf16 a[4:7], v[20:23], v[64:67], a[4:7]
    v_mfma_f32_16x16x32_bf16 a[8:11], v[20:23], v[68:71], a[8:11]
    v_mfma_f32_16x16x32_bf16 a[12:15], v[20:23], v[72:75], a[12:15]
    v_mfma_f32_16x16x32_bf16 a[16:19], v[24:27], v[60:63], a[16:19]
    v_mfma_f32_16x16x32_bf16 a[20:23], v[24:27], v[64:67], a[20:23]
    s_waitcnt vmcnt(0)
    ds_read_b64_tr_b16 v[40:41], v245 offset:5120
    v_mfma_f32_16x16x32_bf16 a[24:27], v[24:27], v[68:71], a[24:27]
    ds_read_b64_tr_b16 v[42:43], v245 offset:7680
    v_mfma_f32_16x16x32_bf16 a[28:31], v[24:27], v[72:75], a[28:31]
    ds_read_b64_tr_b16 v[44:45], v245 offset:5152
    v_mfma_f32_16x16x32_bf16 a[32:35], v[28:31], v[60:63], a[32:35]
    ds_read_b64_tr_b16 v[46:47], v245 offset:7712
    v_mfma_f32_16x16x32_bf16 a[36:39], v[28:31], v[64:67], a[36:39]
    ds_read_b64_tr_b16 v[48:49], v245 offset:5184
    v_mfma_f32_16x16x32_bf16 a[40:43], v[28:31], v[68:71], a[40:43]
    ds_read_b64_tr_b16 v[50:51], v245 offset:7744
    v_mfma_f32_16x16x32_bf16 a[44:47], v[28:31], v[72:75], a[44:47]
    ds_read_b64_tr_b16 v[52:53], v245 offset:5216
    v_mfma_f32_16x16x32_bf16 a[48:51], v[32:35], v[60:63], a[48:51]
    ds_read_b64_tr_b16 v[54:55], v245 offset:7776
    v_mfma_f32_16x16x32_bf16 a[52:55], v[32:35], v[64:67], a[52:55]
    ds_read_b64_tr_b16 v[56:57], v245 offset:5248
    v_mfma_f32_16x16x32_bf16 a[56:59], v[32:35], v[68:71], a[56:59]
    ds_read_b64_tr_b16 v[58:59], v245 offset:7808
    v_mfma_f32_16x16x32_bf16 a[60:63], v[32:35], v[72:75], a[60:63]
    ds_read_b128 v[76:79], v246 offset:1216
    v_mfma_f32_16x16x32_bf16 a[64:67], v[36:39], v[60:63], a[64:67]
    ds_read_b128 v[80:83], v246 offset:21952
    v_mfma_f32_16x16x32_bf16 a[68:71], v[36:39], v[64:67], a[68:71]
    ds_read_b128 v[84:87], v246 offset:42688
    v_mfma_f32_16x16x32_bf16 a[72:75], v[36:39], v[68:71], a[72:75]
    ds_read_b128 v[88:91], v246 offset:63424
    v_mfma_f32_16x16x32_bf16 a[76:79], v[36:39], v[72:75], a[76:79]
    s_waitcnt lgkmcnt(0)
    v_mfma_f32_16x16x32_bf16 a[0:3], v[40:43], v[76:79], a[0:3]
    v_mfma_f32_16x16x32_bf16 a[4:7], v[40:43], v[80:83], a[4:7]
    v_mfma_f32_16x16x32_bf16 a[8:11], v[40:43], v[84:87], a[8:11]
    v_mfma_f32_16x16x32_bf16 a[12:15], v[40:43], v[88:91], a[12:15]
    v_mfma_f32_16x16x32_bf16 a[16:19], v[44:47], v[76:79], a[16:19]
    v_mfma_f32_16x16x32_bf16 a[20:23], v[44:47], v[80:83], a[20:23]
    v_mfma_f32_16x16x32_bf16 a[24:27], v[44:47], v[84:87], a[24:27]
    v_mfma_f32_16x16x32_bf16 a[28:31], v[44:47], v[88:91], a[28:31]
    v_mfma_f32_16x16x32_bf16 a[32:35], v[48:51], v[76:79], a[32:35]
    v_mfma_f32_16x16x32_bf16 a[36:39], v[48:51], v[80:83], a[36:39]
    v_mfma_f32_16x16x32_bf16 a[40:43], v[48:51], v[84:87], a[40:43]
    v_mfma_f32_16x16x32_bf16 a[44:47], v[48:51], v[88:91], a[44:47]
    v_mfma_f32_16x16x32_bf16 a[48:51], v[52:55], v[76:79], a[48:51]
    v_mfma_f32_16x16x32_bf16 a[52:55], v[52:55], v[80:83], a[52:55]
    v_mfma_f32_16x16x32_bf16 a[56:59], v[52:55], v[84:87], a[56:59]
    v_mfma_f32_16x16x32_bf16 a[60:63], v[52:55], v[88:91], a[60:63]
    v_mfma_f32_16x16x32_bf16 a[64:67], v[56:59], v[76:79], a[64:67]
    v_mfma_f32_16x16x32_bf16 a[68:71], v[56:59], v[80:83], a[68:71]
    v_mfma_f32_16x16x32_bf16 a[72:75], v[56:59], v[84:87], a[72:75]
    v_mfma_f32_16x16x32_bf16 a[76:79], v[56:59], v[88:91], a[76:79]
    v_and_b32 v4, 15, v1
    v_mul_u32_u24 v4, 176, v4
    v_lshrrev_b32 v5, 4, v1
    v_lshlrev_b32 v5, 3, v5
    v_add3_u32 v8, v4, v5, s42
    s_mov_b32 s14, 6554
    s_lshl_b32 s15, s39, 1
    s_mul_i32 s48, s36, 1280
    s_add_u32 s48, s48, s15
    v_add_u32 v3, 0, v1
    v_mul_lo_u32 v4, v3, s14
    v_lshrrev_b32 v4, 16, v4
    v_mul_u32_u24 v5, 10, v4
    v_sub_u32 v5, v3, v5
    v_lshlrev_b32 v5, 4, v5
    v_mul_u32_u24 v6, 176, v4
    v_add3_u32 v200, v6, v5, s42
    v_mul_u32_u24 v6, 0x500, v4
    v_add_u32 v210, v6, v5
    v_add_u32 v3, 64, v1
    v_mul_lo_u32 v4, v3, s14
    v_lshrrev_b32 v4, 16, v4
    v_mul_u32_u24 v5, 10, v4
    v_sub_u32 v5, v3, v5
    v_lshlrev_b32 v5, 4, v5
    v_mul_u32_u24 v6, 176, v4
    v_add3_u32 v201, v6, v5, s42
    v_mul_u32_u24 v6, 0x500, v4
    v_add_u32 v211, v6, v5
    v_add_u32 v3, 128, v1
    v_mul_lo_u32 v4, v3, s14
    v_lshrrev_b32 v4, 16, v4
    v_mul_u32_u24 v5, 10, v4
    v_sub_u32 v5, v3, v5
    v_lshlrev_b32 v5, 4, v5
    v_mul_u32_u24 v6, 176, v4
    v_add3_u32 v202, v6, v5, s42
    v_mul_u32_u24 v6, 0x500, v4
    v_add_u32 v212, v6, v5
    v_add_u32 v3, 192, v1
    v_mul_lo_u32 v4, v3, s14
    v_lshrrev_b32 v4, 16, v4
    v_mul_u32_u24 v5, 10, v4
    v_sub_u32 v5, v3, v5
    v_lshlrev_b32 v5, 4, v5
    v_mul_u32_u24 v6, 176, v4
    v_add3_u32 v203, v6, v5, s42
    v_mul_u32_u24 v6, 0x500, v4
    v_add_u32 v213, v6, v5
    v_add_u32 v3, 256, v1
    v_mul_lo_u32 v4, v3, s14
    v_lshrrev_b32 v4, 16, v4
    v_mul_u32_u24 v5, 10, v4
    v_sub_u32 v5, v3, v5
    v_lshlrev_b32 v5, 4, v5
    v_mul_u32_u24 v6, 176, v4
    v_add3_u32 v204, v6, v5, s42
    v_mul_u32_u24 v6, 0x500, v4
    v_add_u32 v214, v6, v5
    v_add_u32 v3, 320, v1
    v_mul_lo_u32 v4, v3, s14
    v_lshrrev_b32 v4, 16, v4
    v_mul_u32_u24 v5, 10, v4
    v_sub_u32 v5, v3, v5
    v_lshlrev_b32 v5, 4, v5
    v_mul_u32_u24 v6, 176, v4
    v_add3_u32 v205, v6, v5, s42
    v_mul_u32_u24 v6, 0x500, v4
    v_add_u32 v215, v6, v5
    v_add_u32 v3, 384, v1
    v_mul_lo_u32 v4, v3, s14
    v_lshrrev_b32 v4, 16, v4
    v_mul_u32_u24 v5, 10, v4
    v_sub_u32 v5, v3, v5
    v_lshlrev_b32 v5, 4, v5
    v_mul_u32_u24 v6, 176, v4
    v_add3_u32 v206, v6, v5, s42
    v_mul_u32_u24 v6, 0x500, v4
    v_add_u32 v216, v6, v5
    v_add_u32 v3, 448, v1
    v_mul_lo_u32 v4, v3, s14
    v_lshrrev_b32 v4, 16, v4
    v_mul_u32_u24 v5, 10, v4
    v_sub_u32 v5, v3, v5
    v_lshlrev_b32 v5, 4, v5
    v_mul_u32_u24 v6, 176, v4
    v_add3_u32 v207, v6, v5, s42
    v_mul_u32_u24 v6, 0x500, v4
    v_add_u32 v217, v6, v5
    v_add_u32 v3, 512, v1
    v_mul_lo_u32 v4, v3, s14
    v_lshrrev_b32 v4, 16, v4
    v_mul_u32_u24 v5, 10, v4
    v_sub_u32 v5, v3, v5
    v_lshlrev_b32 v5, 4, v5
    v_mul_u32_u24 v6, 176, v4
    v_add3_u32 v208, v6, v5, s42
    v_mul_u32_u24 v6, 0x500, v4
    v_add_u32 v218, v6, v5
    v_add_u32 v3, 576, v1
    v_mul_lo_u32 v4, v3, s14
    v_lshrrev_b32 v4, 16, v4
    v_mul_u32_u24 v5, 10, v4
    v_sub_u32 v5, v3, v5
    v_lshlrev_b32 v5, 4, v5
    v_mul_u32_u24 v6, 176, v4
    v_add3_u32 v209, v6, v5, s42
    v_mul_u32_u24 v6, 0x500, v4
    v_add_u32 v219, v6, v5
    s_nop 7
    v_accvgpr_read_b32 v100, a0
    v_accvgpr_read_b32 v101, a1
    v_accvgpr_read_b32 v102, a2
    v_accvgpr_read_b32 v103, a3
    v_cvt_pk_bf16_f32 v104, v100, v101
    v_cvt_pk_bf16_f32 v105, v102, v103
    ds_write_b64 v8, v[104:105] offset:0
    v_accvgpr_read_b32 v108, a16
    v_accvgpr_read_b32 v109, a17
    v_accvgpr_read_b32 v110, a18
    v_accvgpr_read_b32 v111, a19
    v_cvt_pk_bf16_f32 v112, v108, v109
    v_cvt_pk_bf16_f32 v113, v110, v111
    ds_write_b64 v8, v[112:113] offset:32
    v_accvgpr_read_b32 v116, a32
    v_accvgpr_read_b32 v117, a33
    v_accvgpr_read_b32 v118, a34
    v_accvgpr_read_b32 v119, a35
    v_cvt_pk_bf16_f32 v120, v116, v117
    v_cvt_pk_bf16_f32 v121, v118, v119
    ds_write_b64 v8, v[120:121] offset:64
    v_accvgpr_read_b32 v124, a48
    v_accvgpr_read_b32 v125, a49
    v_accvgpr_read_b32 v126, a50
    v_accvgpr_read_b32 v127, a51
    v_cvt_pk_bf16_f32 v128, v124, v125
    v_cvt_pk_bf16_f32 v129, v126, v127
    ds_write_b64 v8, v[128:129] offset:96
    v_accvgpr_read_b32 v132, a64
    v_accvgpr_read_b32 v133, a65
    v_accvgpr_read_b32 v134, a66
    v_accvgpr_read_b32 v135, a67
    v_cvt_pk_bf16_f32 v136, v132, v133
    v_cvt_pk_bf16_f32 v137, v134, v135
    ds_write_b64 v8, v[136:137] offset:128
    v_accvgpr_read_b32 v140, a4
    v_accvgpr_read_b32 v141, a5
    v_accvgpr_read_b32 v142, a6
    v_accvgpr_read_b32 v143, a7
    v_cvt_pk_bf16_f32 v144, v140, v141
    v_cvt_pk_bf16_f32 v145, v142, v143
    ds_write_b64 v8, v[144:145] offset:2816
    v_accvgpr_read_b32 v148, a20
    v_accvgpr_read_b32 v149, a21
    v_accvgpr_read_b32 v150, a22
    v_accvgpr_read_b32 v151, a23
    v_cvt_pk_bf16_f32 v152, v148, v149
    v_cvt_pk_bf16_f32 v153, v150, v151
    ds_write_b64 v8, v[152:153] offset:2848
    v_accvgpr_read_b32 v156, a36
    v_accvgpr_read_b32 v157, a37
    v_accvgpr_read_b32 v158, a38
    v_accvgpr_read_b32 v159, a39
    v_cvt_pk_bf16_f32 v160, v156, v157
    v_cvt_pk_bf16_f32 v161, v158, v159
    ds_write_b64 v8, v[160:161] offset:2880
    v_accvgpr_read_b32 v100, a52
    v_accvgpr_read_b32 v101, a53
    v_accvgpr_read_b32 v102, a54
    v_accvgpr_read_b32 v103, a55
    v_cvt_pk_bf16_f32 v104, v100, v101
    v_cvt_pk_bf16_f32 v105, v102, v103
    ds_write_b64 v8, v[104:105] offset:2912
    v_accvgpr_read_b32 v108, a68
    v_accvgpr_read_b32 v109, a69
    v_accvgpr_read_b32 v110, a70
    v_accvgpr_read_b32 v111, a71
    v_cvt_pk_bf16_f32 v112, v108, v109
    v_cvt_pk_bf16_f32 v113, v110, v111
    ds_write_b64 v8, v[112:113] offset:2944
    v_accvgpr_read_b32 v116, a8
    v_accvgpr_read_b32 v117, a9
    v_accvgpr_read_b32 v118, a10
    v_accvgpr_read_b32 v119, a11
    v_cvt_pk_bf16_f32 v120, v116, v117
    v_cvt_pk_bf16_f32 v121, v118, v119
    ds_write_b64 v8, v[120:121] offset:5632
    v_accvgpr_read_b32 v124, a24
    v_accvgpr_read_b32 v125, a25
    v_accvgpr_read_b32 v126, a26
    v_accvgpr_read_b32 v127, a27
    v_cvt_pk_bf16_f32 v128, v124, v125
    v_cvt_pk_bf16_f32 v129, v126, v127
    ds_write_b64 v8, v[128:129] offset:5664
    v_accvgpr_read_b32 v132, a40
    v_accvgpr_read_b32 v133, a41
    v_accvgpr_read_b32 v134, a42
    v_accvgpr_read_b32 v135, a43
    v_cvt_pk_bf16_f32 v136, v132, v133
    v_cvt_pk_bf16_f32 v137, v134, v135
    ds_write_b64 v8, v[136:137] offset:5696
    v_accvgpr_read_b32 v140, a56
    v_accvgpr_read_b32 v141, a57
    v_accvgpr_read_b32 v142, a58
    v_accvgpr_read_b32 v143, a59
    v_cvt_pk_bf16_f32 v144, v140, v141
    v_cvt_pk_bf16_f32 v145, v142, v143
    ds_write_b64 v8, v[144:145] offset:5728
    v_accvgpr_read_b32 v148, a72
    v_accvgpr_read_b32 v149, a73
    v_accvgpr_read_b32 v150, a74
    v_accvgpr_read_b32 v151, a75
    v_cvt_pk_bf16_f32 v152, v148, v149
    v_cvt_pk_bf16_f32 v153, v150, v151
    ds_write_b64 v8, v[152:153] offset:5760
    v_accvgpr_read_b32 v156, a12
    v_accvgpr_read_b32 v157, a13
    v_accvgpr_read_b32 v158, a14
    v_accvgpr_read_b32 v159, a15
    v_cvt_pk_bf16_f32 v160, v156, v157
    v_cvt_pk_bf16_f32 v161, v158, v159
    ds_write_b64 v8, v[160:161] offset:8448
    v_accvgpr_read_b32 v100, a28
    v_accvgpr_read_b32 v101, a29
    v_accvgpr_read_b32 v102, a30
    v_accvgpr_read_b32 v103, a31
    v_cvt_pk_bf16_f32 v104, v100, v101
    v_cvt_pk_bf16_f32 v105, v102, v103
    ds_write_b64 v8, v[104:105] offset:8480
    v_accvgpr_read_b32 v108, a44
    v_accvgpr_read_b32 v109, a45
    v_accvgpr_read_b32 v110, a46
    v_accvgpr_read_b32 v111, a47
    v_cvt_pk_bf16_f32 v112, v108, v109
    v_cvt_pk_bf16_f32 v113, v110, v111
    ds_write_b64 v8, v[112:113] offset:8512
    v_accvgpr_read_b32 v116, a60
    v_accvgpr_read_b32 v117, a61
    v_accvgpr_read_b32 v118, a62
    v_accvgpr_read_b32 v119, a63
    v_cvt_pk_bf16_f32 v120, v116, v117
    v_cvt_pk_bf16_f32 v121, v118, v119
    ds_write_b64 v8, v[120:121] offset:8544
    v_accvgpr_read_b32 v124, a76
    v_accvgpr_read_b32 v125, a77
    v_accvgpr_read_b32 v126, a78
    v_accvgpr_read_b32 v127, a79
    v_cvt_pk_bf16_f32 v128, v124, v125
    v_cvt_pk_bf16_f32 v129, v126, v127
    ds_write_b64 v8, v[128:129] offset:8576
    s_waitcnt lgkmcnt(0)
    ds_read_b128 v[20:23], v200
    ds_read_b128 v[24:27], v201
    ds_read_b128 v[28:31], v202
    ds_read_b128 v[32:35], v203
    ds_read_b128 v[36:39], v204
    ds_read_b128 v[40:43], v205
    ds_read_b128 v[44:47], v206
    ds_read_b128 v[48:51], v207
    ds_read_b128 v[52:55], v208
    ds_read_b128 v[56:59], v209
    s_waitcnt lgkmcnt(9)
    buffer_store_dwordx4 v[20:23], v210, s[32:35], s48 offen
    s_waitcnt lgkmcnt(8)
    buffer_store_dwordx4 v[24:27], v211, s[32:35], s48 offen
    s_waitcnt lgkmcnt(7)
    buffer_store_dwordx4 v[28:31], v212, s[32:35], s48 offen
    s_waitcnt lgkmcnt(6)
    buffer_store_dwordx4 v[32:35], v213, s[32:35], s48 offen
    s_waitcnt lgkmcnt(5)
    buffer_store_dwordx4 v[36:39], v214, s[32:35], s48 offen
    s_waitcnt lgkmcnt(4)
    buffer_store_dwordx4 v[40:43], v215, s[32:35], s48 offen
    s_waitcnt lgkmcnt(3)
    buffer_store_dwordx4 v[44:47], v216, s[32:35], s48 offen
    s_waitcnt lgkmcnt(2)
    buffer_store_dwordx4 v[48:51], v217, s[32:35], s48 offen
    s_waitcnt lgkmcnt(1)
    buffer_store_dwordx4 v[52:55], v218, s[32:35], s48 offen
    s_waitcnt lgkmcnt(0)
    buffer_store_dwordx4 v[56:59], v219, s[32:35], s48 offen
L_end:
s_endpgm
.section .rodata,"a"
.p2align 6
.amdhsa_kernel standalone__layernorm_linear__sampling_kernel
  .amdhsa_next_free_vgpr 336
  .amdhsa_next_free_sgpr 102
  .amdhsa_accum_offset 256
  .amdhsa_group_segment_fixed_size 0
  .amdhsa_kernarg_size 56
  .amdhsa_user_sgpr_count 2
  .amdhsa_user_sgpr_kernarg_segment_ptr 1
  .amdhsa_system_sgpr_workgroup_id_x 1
.end_amdhsa_kernel
```
